```python
import torch

def _softmax(x, axis=-1):
    return torch.softmax(x, dim=axis)
def _gelu(x):
    return torch.nn.functional.gelu(x, approximate="tanh")
def _silu(x):
    return torch.nn.functional.silu(x)
def _sigmoid(x):
    return torch.sigmoid(x)
def _layernorm(x, axis=-1, eps=1e-5):
    m = x.mean(dim=axis, keepdim=True)
    v = x.var(dim=axis, keepdim=True, unbiased=False)
    return (x - m) / torch.sqrt(v + eps)
def _scatter_add(tgt, idx, src, axis=0):
    return tgt.clone().index_add_(axis, idx, src)
def _segment_sum(src, seg, n):
    out = torch.zeros((n,) + src.shape[1:], dtype=src.dtype)
    return out.index_add_(0, seg, src)
def _pad(x, pw):
    flat = tuple(v for pair in reversed(pw) for v in pair)
    return torch.nn.functional.pad(x, flat)

kernel_name = 'sequential_preLN__mha_block__dense_activation_squared_relu__prompt'

def setup_inputs():

    _w = (lambda a: (lambda t: t.to(torch.bfloat16) if t.is_floating_point() else t)(torch.as_tensor(a)))
    def _A_setup():
        B, S, D, H = 1, 2048, 512, 32
        return {
            "x": _w((lambda *s: torch.randn(*s, dtype=torch.bfloat16) * 0.05)(B, S, D)),
            "wqkv": _w((lambda *s: torch.randn(*s, dtype=torch.bfloat16) * 0.05)(D, 3 * D)),
            "wo": _w((lambda *s: torch.randn(*s, dtype=torch.bfloat16) * 0.05)(D, D)),
        }
    _A_in = _A_setup()

    def _B_setup():
        B, S, D, F = 1, 2048, 512, 1376
        return {
            "x": _w((lambda *s: torch.randn(*s, dtype=torch.bfloat16) * 0.05)(B, S, D)),
            "w1": _w((lambda *s: torch.randn(*s, dtype=torch.bfloat16) * 0.05)(D, F)),
            "b1": _w((lambda *s: torch.randn(*s, dtype=torch.bfloat16) * 0.4)(F)),
            "w2": _w((lambda *s: torch.randn(*s, dtype=torch.bfloat16) * 0.05)(F, D)),
            "b2": _w((lambda *s: torch.randn(*s, dtype=torch.bfloat16) * 1.6)(D)),
        }
    _B_in = _B_setup()

    return {
        "A_x": _A_in["x"],
        "A_wqkv": _A_in["wqkv"],
        "A_wo": _A_in["wo"],
        "B_x": _B_in["x"],
        "B_w1": _B_in["w1"],
        "B_b1": _B_in["b1"],
        "B_w2": _B_in["w2"],
        "B_b2": _B_in["b2"],
    }

def reference(A_x, A_wqkv, A_wo, B_x, B_w1, B_b1, B_w2, B_b2):
    def _A_ref(x, wqkv, wo):
        B, S, D = x.shape
        H = 32
        Dh = D // H
        qkv = (lambda x, *d: x.permute(*d))((x @ wqkv).reshape(B, S, 3, H, Dh), 2, 0, 3, 1, 4)
        q, k, v = qkv[0], qkv[1], qkv[2]
        scores = torch.einsum("bhqd,bhkd->bhqk", q, k) * (Dh ** -0.5)
        p = _softmax(scores, axis=-1)
        o = torch.einsum("bhqk,bhkd->bhqd", p, v)
        return (lambda x, *d: x.permute(*d))(o, 0, 2, 1, 3).reshape(B, S, D) @ wo

    def _B_ref(x, w1, b1, w2, b2):
        h = torch.einsum("bsd,df->bsf", x, w1) + b1
        zero = torch.zeros_like(h)
        r = torch.where(h > zero, h, zero)
        h = r * r
        out = torch.einsum("bsf,fd->bsd", h, w2) + b2
        return out

    x = A_x
    h = x + _A_ref(_layernorm(x, axis=-1), A_wqkv, A_wo)
    h2 = h + _B_ref(_layernorm(h, axis=-1), B_w1, B_b1, B_w2, B_b2)
    return h2
```

```asm
; @launch grid=(256,1,1) block=(512,1,1) lds=163840
.amdgcn_target "amdgcn-amd-amdhsa--gfx950"
.text
.globl sequential_preLN__mha_block__dense_activation_squared_relu__prompt_kernel
.p2align 8
.type sequential_preLN__mha_block__dense_activation_squared_relu__prompt_kernel,@function
sequential_preLN__mha_block__dense_activation_squared_relu__prompt_kernel:
  s_cmp_ge_u32 s2, 256
  s_cbranch_scc1 sequential_preLN__mha_block__dense_activation_squared_relu__prompt_kernel_end
  s_load_dwordx8 s[24:31], s[0:1], 0
  s_load_dwordx8 s[32:39], s[0:1], 32
  s_load_dwordx4 s[40:43], s[0:1], 64
  s_load_dwordx2 s[44:45], s[0:1], 80
  v_lshrrev_b32 v1, 6, v0
  v_and_b32 v0, 63, v0
  s_mov_b32 s4, 0
  v_readfirstlane_b32 s3, v1
  s_waitcnt lgkmcnt(0)
  s_mov_b32 s8, s44
  s_and_b32 s9, s45, 0xffff
  s_mov_b32 s10, 26214400
  s_mov_b32 s11, 0x20000
  s_mov_b32 s12, s24
  s_and_b32 s13, s25, 0xffff
  s_mov_b32 s14, 2097152
  s_mov_b32 s15, 0x20000
  s_mov_b32 s16, s26
  s_and_b32 s17, s27, 0xffff
  s_mov_b32 s18, 1572864
  s_mov_b32 s19, 0x20000
  s_mov_b32 s20, s42
  s_and_b32 s21, s43, 0xffff
  s_mov_b32 s22, 256
  s_mov_b32 s23, 0x20000
sequential_preLN__mha_block__dense_activation_squared_relu__prompt_kernel_tk_1:
  s_or_b32 s5, s2, s3
  s_cmp_lg_u32 s5, 0
  s_cbranch_scc1 sequential_preLN__mha_block__dense_activation_squared_relu__prompt_kernel_nn_2
  s_memrealtime s[46:47]
  s_waitcnt lgkmcnt(0)
  s_or_b32 s46, s46, 1
  v_mov_b32 v2, 0
  v_mov_b32 v3, s46
  s_mov_b64 exec, 1
  buffer_store_dword v3, v2, s[20:23], 0 offen sc1
  s_mov_b64 exec, -1
sequential_preLN__mha_block__dense_activation_squared_relu__prompt_kernel_nn_2:
  s_and_b32 s48, s2, 7
  s_lshr_b32 s49, s2, 3
  s_and_b32 s46, s48, 3
  s_lshl_b32 s46, s46, 2
  s_and_b32 s50, s49, 3
  s_add_u32 s46, s46, s50
  s_lshr_b32 s47, s48, 2
  s_lshl_b32 s47, s47, 3
  s_lshr_b32 s50, s49, 2
  s_add_u32 s47, s47, s50
  s_cmp_ge_u32 s3, 4
  s_cbranch_scc1 sequential_preLN__mha_block__dense_activation_squared_relu__prompt_kernel_A_helper
  v_and_b32 v8, 31, v0
  v_lshrrev_b32 v9, 5, v0
  s_lshl_b32 s50, s3, 5
  v_add_u32 v10, s50, v8
  v_lshlrev_b32 v10, 7, v10
  v_lshrrev_b32 v11, 1, v0
  v_and_b32 v11, 7, v11
  v_add_u32 v12, 0, v9
  v_xor_b32 v12, v12, v11
  v_lshl_add_u32 v2, v12, 4, v10
  v_add_u32 v12, 2, v9
  v_xor_b32 v12, v12, v11
  v_lshl_add_u32 v3, v12, 4, v10
  v_add_u32 v12, 4, v9
  v_xor_b32 v12, v12, v11
  v_lshl_add_u32 v4, v12, 4, v10
  v_add_u32 v12, 6, v9
  v_xor_b32 v12, v12, v11
  v_lshl_add_u32 v5, v12, 4, v10
  v_bfe_u32 v12, v0, 2, 2
  v_lshl_add_u32 v12, v9, 3, v12
  v_mul_u32_u24 v12, 192, v12
  v_bfe_u32 v13, v0, 4, 1
  v_lshl_add_u32 v12, v13, 5, v12
  v_and_b32 v13, 3, v0
  v_lshl_add_u32 v12, v13, 3, v12
  v_add_u32 v6, 16384, v12
  v_mov_b32 v16, 0
  v_mov_b32 v17, 0
  v_mov_b32 v18, 0
  v_mov_b32 v19, 0
  v_mov_b32 v20, 0
  v_mov_b32 v21, 0
  v_mov_b32 v22, 0
  v_mov_b32 v23, 0
  v_mov_b32 v24, 0
  v_mov_b32 v25, 0
  v_mov_b32 v26, 0
  v_mov_b32 v27, 0
  v_mov_b32 v28, 0
  v_mov_b32 v29, 0
  v_mov_b32 v30, 0
  v_mov_b32 v31, 0
  v_mov_b32 v32, 0
  v_mov_b32 v33, 0
  v_mov_b32 v34, 0
  v_mov_b32 v35, 0
  v_mov_b32 v36, 0
  v_mov_b32 v37, 0
  v_mov_b32 v38, 0
  v_mov_b32 v39, 0
  v_mov_b32 v40, 0
  v_mov_b32 v41, 0
  v_mov_b32 v42, 0
  v_mov_b32 v43, 0
  v_mov_b32 v44, 0
  v_mov_b32 v45, 0
  v_mov_b32 v46, 0
  v_mov_b32 v47, 0
  v_mov_b32 v48, 0
  v_mov_b32 v49, 0
  v_mov_b32 v50, 0
  v_mov_b32 v51, 0
  v_mov_b32 v52, 0
  v_mov_b32 v53, 0
  v_mov_b32 v54, 0
  v_mov_b32 v55, 0
  v_mov_b32 v56, 0
  v_mov_b32 v57, 0
  v_mov_b32 v58, 0
  v_mov_b32 v59, 0
  v_mov_b32 v60, 0
  v_mov_b32 v61, 0
  v_mov_b32 v62, 0
  v_mov_b32 v63, 0
  v_mov_b32 v120, 0
  v_mov_b32 v121, 0
  v_mov_b32 v122, 0
  v_mov_b32 v123, 0
  v_mov_b32 v124, 0
  v_mov_b32 v125, 0
  v_mov_b32 v126, 0
  v_mov_b32 v127, 0
  v_mov_b32 v128, 0x3f803f80
  s_mov_b32 s52, 0
  s_mov_b32 s53, 28672
  s_mov_b32 s54, 4294852608
  s_barrier
  ds_read_b128 v[64:67], v2
  ds_read_b64_tr_b16 v[96:97], v6 offset:0
  ds_read_b64_tr_b16 v[98:99], v6 offset:768
  ds_read_b64_tr_b16 v[100:101], v6 offset:64
  ds_read_b64_tr_b16 v[102:103], v6 offset:832
  ds_read_b64_tr_b16 v[104:105], v6 offset:128
  ds_read_b64_tr_b16 v[106:107], v6 offset:896
  s_cmp_eq_u32 s3, 0
  s_cbranch_scc1 sequential_preLN__mha_block__dense_activation_squared_relu__prompt_kernel_cp_3
  s_getpc_b64 s[56:57]
sequential_preLN__mha_block__dense_activation_squared_relu__prompt_kernel_pc:
  s_lshr_b32 s58, s2, 3
  s_and_b32 s58, s58, 3
  s_mul_i32 s58, s58, 3
  s_add_u32 s58, s58, s3
  s_sub_u32 s58, s58, 1
  s_lshl_b32 s58, s58, 13
  v_lshlrev_b32 v154, 7, v0
  v_add_u32 v154, s58, v154
  v_min_u32 v154, sequential_preLN__mha_block__dense_activation_squared_relu__prompt_kernel_codeend-sequential_preLN__mha_block__dense_activation_squared_relu__prompt_kernel_pc-4, v154
  v_and_b32 v154, 0xfffffffc, v154
  global_load_dword v155, v154, s[56:57]
sequential_preLN__mha_block__dense_activation_squared_relu__prompt_kernel_cp_3:
  s_cmp_ge_u32 s47, 11
  s_cbranch_scc1 sequential_preLN__mha_block__dense_activation_squared_relu__prompt_kernel_av2_5
  s_cmp_eq_u32 s47, 10
  s_cbranch_scc1 sequential_preLN__mha_block__dense_activation_squared_relu__prompt_kernel_av1_4
  s_mov_b32 s55, 0
  .p2align 3
sequential_preLN__mha_block__dense_activation_squared_relu__prompt_kernel_al_7:
  s_waitcnt lgkmcnt(4)
  v_mfma_f32_32x32x16_bf16 v[16:31], v[96:99], v[64:67], v[16:31]
  ds_read_b128 v[68:71], v3
  ds_read_b64_tr_b16 v[108:109], v6 offset:3072
  ds_read_b64_tr_b16 v[110:111], v6 offset:3840
  s_waitcnt lgkmcnt(5)
  v_mfma_f32_32x32x16_bf16 v[32:47], v[100:103], v[64:67], v[32:47]
  ds_read_b64_tr_b16 v[112:113], v6 offset:3136
  ds_read_b64_tr_b16 v[114:115], v6 offset:3904
  s_waitcnt lgkmcnt(5)
  v_mfma_f32_32x32x16_bf16 v[48:63], v[104:107], v[64:67], v[48:63]
  ds_read_b64_tr_b16 v[116:117], v6 offset:3200
  ds_read_b64_tr_b16 v[118:119], v6 offset:3968
  s_waitcnt lgkmcnt(4)
  v_mfma_f32_32x32x16_bf16 v[16:31], v[108:111], v[68:71], v[16:31]
  ds_read_b128 v[72:75], v4
  ds_read_b64_tr_b16 v[96:97], v6 offset:6144
  ds_read_b64_tr_b16 v[98:99], v6 offset:6912
  s_waitcnt lgkmcnt(5)
  v_mfma_f32_32x32x16_bf16 v[32:47], v[112:115], v[68:71], v[32:47]
  ds_read_b64_tr_b16 v[100:101], v6 offset:6208
  ds_read_b64_tr_b16 v[102:103], v6 offset:6976
  s_waitcnt lgkmcnt(5)
  v_mfma_f32_32x32x16_bf16 v[48:63], v[116:119], v[68:71], v[48:63]
  ds_read_b64_tr_b16 v[104:105], v6 offset:6272
  ds_read_b64_tr_b16 v[106:107], v6 offset:7040
  s_waitcnt lgkmcnt(4)
  v_mfma_f32_32x32x16_bf16 v[16:31], v[96:99], v[72:75], v[16:31]
  ds_read_b128 v[76:79], v5
  ds_read_b64_tr_b16 v[108:109], v6 offset:9216
  ds_read_b64_tr_b16 v[110:111], v6 offset:9984
  s_waitcnt lgkmcnt(5)
  v_mfma_f32_32x32x16_bf16 v[32:47], v[100:103], v[72:75], v[32:47]
  ds_read_b64_tr_b16 v[112:113], v6 offset:9280
  ds_read_b64_tr_b16 v[114:115], v6 offset:10048
  s_waitcnt lgkmcnt(5)
  v_mfma_f32_32x32x16_bf16 v[48:63], v[104:107], v[72:75], v[48:63]
  ds_read_b64_tr_b16 v[116:117], v6 offset:9344
  ds_read_b64_tr_b16 v[118:119], v6 offset:10112
  s_add_u32 s52, s52, 1
  s_cmp_eq_u32 s52, 5
  s_cselect_b32 s51, s54, s53
  s_cselect_b32 s52, 0, s52
  v_add_u32 v2, s51, v2
  v_add_u32 v3, s51, v3
  v_add_u32 v4, s51, v4
  v_add_u32 v5, s51, v5
  v_add_u32 v6, s51, v6
  s_waitcnt lgkmcnt(4)
  v_mfma_f32_32x32x16_bf16 v[16:31], v[108:111], v[76:79], v[16:31]
  s_barrier
  ds_read_b128 v[80:83], v2
  ds_read_b64_tr_b16 v[96:97], v6 offset:0
  ds_read_b64_tr_b16 v[98:99], v6 offset:768
  s_waitcnt lgkmcnt(5)
  v_mfma_f32_32x32x16_bf16 v[32:47], v[112:115], v[76:79], v[32:47]
  ds_read_b64_tr_b16 v[100:101], v6 offset:64
  ds_read_b64_tr_b16 v[102:103], v6 offset:832
  s_waitcnt lgkmcnt(5)
  v_mfma_f32_32x32x16_bf16 v[48:63], v[116:119], v[76:79], v[48:63]
  ds_read_b64_tr_b16 v[104:105], v6 offset:128
  ds_read_b64_tr_b16 v[106:107], v6 offset:896
  v_dot2_f32_bf16 v120, v64, v128, v120
  v_dot2_f32_bf16 v124, v64, v64, v124
  v_dot2_f32_bf16 v121, v65, v128, v121
  v_dot2_f32_bf16 v125, v65, v65, v125
  v_dot2_f32_bf16 v122, v66, v128, v122
  v_dot2_f32_bf16 v126, v66, v66, v126
  v_dot2_f32_bf16 v123, v67, v128, v123
  v_dot2_f32_bf16 v127, v67, v67, v127
  v_dot2_f32_bf16 v120, v68, v128, v120
  v_dot2_f32_bf16 v124, v68, v68, v124
  v_dot2_f32_bf16 v121, v69, v128, v121
  v_dot2_f32_bf16 v125, v69, v69, v125
  v_dot2_f32_bf16 v122, v70, v128, v122
  v_dot2_f32_bf16 v126, v70, v70, v126
  v_dot2_f32_bf16 v123, v71, v128, v123
  v_dot2_f32_bf16 v127, v71, v71, v127
  v_dot2_f32_bf16 v120, v72, v128, v120
  v_dot2_f32_bf16 v124, v72, v72, v124
  v_dot2_f32_bf16 v121, v73, v128, v121
  v_dot2_f32_bf16 v125, v73, v73, v125
  v_dot2_f32_bf16 v122, v74, v128, v122
  v_dot2_f32_bf16 v126, v74, v74, v126
  v_dot2_f32_bf16 v123, v75, v128, v123
  v_dot2_f32_bf16 v127, v75, v75, v127
  v_dot2_f32_bf16 v120, v76, v128, v120
  v_dot2_f32_bf16 v124, v76, v76, v124
  v_dot2_f32_bf16 v121, v77, v128, v121
  v_dot2_f32_bf16 v125, v77, v77, v125
  v_dot2_f32_bf16 v122, v78, v128, v122
  v_dot2_f32_bf16 v126, v78, v78, v126
  v_dot2_f32_bf16 v123, v79, v128, v123
  v_dot2_f32_bf16 v127, v79, v79, v127
  s_cmp_eq_u32 s55, 2
  s_cbranch_scc0 sequential_preLN__mha_block__dense_activation_squared_relu__prompt_kernel_nn2_8
  s_cmp_lg_u32 s3, 0
  s_cbranch_scc1 sequential_preLN__mha_block__dense_activation_squared_relu__prompt_kernel_nw0_9
  v_mov_b32 v149, 0
  buffer_load_dword v148, v149, s[20:23], 0 offen sc1
sequential_preLN__mha_block__dense_activation_squared_relu__prompt_kernel_nw0_9:
sequential_preLN__mha_block__dense_activation_squared_relu__prompt_kernel_nn2_8:
  s_waitcnt lgkmcnt(4)
  v_mfma_f32_32x32x16_bf16 v[16:31], v[96:99], v[80:83], v[16:31]
  ds_read_b128 v[84:87], v3
  ds_read_b64_tr_b16 v[108:109], v6 offset:3072
  ds_read_b64_tr_b16 v[110:111], v6 offset:3840
  s_waitcnt lgkmcnt(5)
  v_mfma_f32_32x32x16_bf16 v[32:47], v[100:103], v[80:83], v[32:47]
  ds_read_b64_tr_b16 v[112:113], v6 offset:3136
  ds_read_b64_tr_b16 v[114:115], v6 offset:3904
  s_waitcnt lgkmcnt(5)
  v_mfma_f32_32x32x16_bf16 v[48:63], v[104:107], v[80:83], v[48:63]
  ds_read_b64_tr_b16 v[116:117], v6 offset:3200
  ds_read_b64_tr_b16 v[118:119], v6 offset:3968
  s_waitcnt lgkmcnt(4)
  v_mfma_f32_32x32x16_bf16 v[16:31], v[108:111], v[84:87], v[16:31]
  ds_read_b128 v[88:91], v4
  ds_read_b64_tr_b16 v[96:97], v6 offset:6144
  ds_read_b64_tr_b16 v[98:99], v6 offset:6912
  s_waitcnt lgkmcnt(5)
  v_mfma_f32_32x32x16_bf16 v[32:47], v[112:115], v[84:87], v[32:47]
  ds_read_b64_tr_b16 v[100:101], v6 offset:6208
  ds_read_b64_tr_b16 v[102:103], v6 offset:6976
  s_waitcnt lgkmcnt(5)
  v_mfma_f32_32x32x16_bf16 v[48:63], v[116:119], v[84:87], v[48:63]
  ds_read_b64_tr_b16 v[104:105], v6 offset:6272
  ds_read_b64_tr_b16 v[106:107], v6 offset:7040
  s_waitcnt lgkmcnt(4)
  v_mfma_f32_32x32x16_bf16 v[16:31], v[96:99], v[88:91], v[16:31]
  ds_read_b128 v[92:95], v5
  ds_read_b64_tr_b16 v[108:109], v6 offset:9216
  ds_read_b64_tr_b16 v[110:111], v6 offset:9984
  s_waitcnt lgkmcnt(5)
  v_mfma_f32_32x32x16_bf16 v[32:47], v[100:103], v[88:91], v[32:47]
  ds_read_b64_tr_b16 v[112:113], v6 offset:9280
  ds_read_b64_tr_b16 v[114:115], v6 offset:10048
  s_waitcnt lgkmcnt(5)
  v_mfma_f32_32x32x16_bf16 v[48:63], v[104:107], v[88:91], v[48:63]
  ds_read_b64_tr_b16 v[116:117], v6 offset:9344
  ds_read_b64_tr_b16 v[118:119], v6 offset:10112
  s_add_u32 s52, s52, 1
  s_cmp_eq_u32 s52, 5
  s_cselect_b32 s51, s54, s53
  s_cselect_b32 s52, 0, s52
  v_add_u32 v2, s51, v2
  v_add_u32 v3, s51, v3
  v_add_u32 v4, s51, v4
  v_add_u32 v5, s51, v5
  v_add_u32 v6, s51, v6
  s_waitcnt lgkmcnt(4)
  v_mfma_f32_32x32x16_bf16 v[16:31], v[108:111], v[92:95], v[16:31]
  s_barrier
  ds_read_b128 v[64:67], v2
  ds_read_b64_tr_b16 v[96:97], v6 offset:0
  ds_read_b64_tr_b16 v[98:99], v6 offset:768
  s_waitcnt lgkmcnt(5)
  v_mfma_f32_32x32x16_bf16 v[32:47], v[112:115], v[92:95], v[32:47]
  ds_read_b64_tr_b16 v[100:101], v6 offset:64
  ds_read_b64_tr_b16 v[102:103], v6 offset:832
  s_waitcnt lgkmcnt(5)
  v_mfma_f32_32x32x16_bf16 v[48:63], v[116:119], v[92:95], v[48:63]
  ds_read_b64_tr_b16 v[104:105], v6 offset:128
  ds_read_b64_tr_b16 v[106:107], v6 offset:896
  v_dot2_f32_bf16 v120, v80, v128, v120
  v_dot2_f32_bf16 v124, v80, v80, v124
  v_dot2_f32_bf16 v121, v81, v128, v121
  v_dot2_f32_bf16 v125, v81, v81, v125
  v_dot2_f32_bf16 v122, v82, v128, v122
  v_dot2_f32_bf16 v126, v82, v82, v126
  v_dot2_f32_bf16 v123, v83, v128, v123
  v_dot2_f32_bf16 v127, v83, v83, v127
  v_dot2_f32_bf16 v120, v84, v128, v120
  v_dot2_f32_bf16 v124, v84, v84, v124
  v_dot2_f32_bf16 v121, v85, v128, v121
  v_dot2_f32_bf16 v125, v85, v85, v125
  v_dot2_f32_bf16 v122, v86, v128, v122
  v_dot2_f32_bf16 v126, v86, v86, v126
  v_dot2_f32_bf16 v123, v87, v128, v123
  v_dot2_f32_bf16 v127, v87, v87, v127
  v_dot2_f32_bf16 v120, v88, v128, v120
  v_dot2_f32_bf16 v124, v88, v88, v124
  v_dot2_f32_bf16 v121, v89, v128, v121
  v_dot2_f32_bf16 v125, v89, v89, v125
  v_dot2_f32_bf16 v122, v90, v128, v122
  v_dot2_f32_bf16 v126, v90, v90, v126
  v_dot2_f32_bf16 v123, v91, v128, v123
  v_dot2_f32_bf16 v127, v91, v91, v127
  v_dot2_f32_bf16 v120, v92, v128, v120
  v_dot2_f32_bf16 v124, v92, v92, v124
  v_dot2_f32_bf16 v121, v93, v128, v121
  v_dot2_f32_bf16 v125, v93, v93, v125
  v_dot2_f32_bf16 v122, v94, v128, v122
  v_dot2_f32_bf16 v126, v94, v94, v126
  v_dot2_f32_bf16 v123, v95, v128, v123
  v_dot2_f32_bf16 v127, v95, v95, v127
  s_add_u32 s55, s55, 1
  s_cmp_lt_u32 s55, 3
  s_cbranch_scc1 sequential_preLN__mha_block__dense_activation_squared_relu__prompt_kernel_al_7
  s_waitcnt lgkmcnt(4)
  v_mfma_f32_32x32x16_bf16 v[16:31], v[96:99], v[64:67], v[16:31]
  ds_read_b128 v[68:71], v3
  ds_read_b64_tr_b16 v[108:109], v6 offset:3072
  ds_read_b64_tr_b16 v[110:111], v6 offset:3840
  s_waitcnt lgkmcnt(5)
  v_mfma_f32_32x32x16_bf16 v[32:47], v[100:103], v[64:67], v[32:47]
  ds_read_b64_tr_b16 v[112:113], v6 offset:3136
  ds_read_b64_tr_b16 v[114:115], v6 offset:3904
  s_waitcnt lgkmcnt(5)
  v_mfma_f32_32x32x16_bf16 v[48:63], v[104:107], v[64:67], v[48:63]
  ds_read_b64_tr_b16 v[116:117], v6 offset:3200
  ds_read_b64_tr_b16 v[118:119], v6 offset:3968
  s_waitcnt lgkmcnt(4)
  v_mfma_f32_32x32x16_bf16 v[16:31], v[108:111], v[68:71], v[16:31]
  ds_read_b128 v[72:75], v4
  ds_read_b64_tr_b16 v[96:97], v6 offset:6144
  ds_read_b64_tr_b16 v[98:99], v6 offset:6912
  s_waitcnt lgkmcnt(5)
  v_mfma_f32_32x32x16_bf16 v[32:47], v[112:115], v[68:71], v[32:47]
  ds_read_b64_tr_b16 v[100:101], v6 offset:6208
  ds_read_b64_tr_b16 v[102:103], v6 offset:6976
  s_waitcnt lgkmcnt(5)
  v_mfma_f32_32x32x16_bf16 v[48:63], v[116:119], v[68:71], v[48:63]
  ds_read_b64_tr_b16 v[104:105], v6 offset:6272
  ds_read_b64_tr_b16 v[106:107], v6 offset:7040
  s_waitcnt lgkmcnt(4)
  v_mfma_f32_32x32x16_bf16 v[16:31], v[96:99], v[72:75], v[16:31]
  ds_read_b128 v[76:79], v5
  ds_read_b64_tr_b16 v[108:109], v6 offset:9216
  ds_read_b64_tr_b16 v[110:111], v6 offset:9984
  s_waitcnt lgkmcnt(5)
  v_mfma_f32_32x32x16_bf16 v[32:47], v[100:103], v[72:75], v[32:47]
  ds_read_b64_tr_b16 v[112:113], v6 offset:9280
  ds_read_b64_tr_b16 v[114:115], v6 offset:10048
  s_waitcnt lgkmcnt(5)
  v_mfma_f32_32x32x16_bf16 v[48:63], v[104:107], v[72:75], v[48:63]
  ds_read_b64_tr_b16 v[116:117], v6 offset:9344
  ds_read_b64_tr_b16 v[118:119], v6 offset:10112
  s_add_u32 s52, s52, 1
  s_cmp_eq_u32 s52, 5
  s_cselect_b32 s51, s54, s53
  s_cselect_b32 s52, 0, s52
  v_add_u32 v2, s51, v2
  v_add_u32 v3, s51, v3
  v_add_u32 v4, s51, v4
  v_add_u32 v5, s51, v5
  v_add_u32 v6, s51, v6
  s_waitcnt lgkmcnt(4)
  v_mfma_f32_32x32x16_bf16 v[16:31], v[108:111], v[76:79], v[16:31]
  s_barrier
  ds_read_b128 v[80:83], v2
  ds_read_b64_tr_b16 v[96:97], v6 offset:0
  ds_read_b64_tr_b16 v[98:99], v6 offset:768
  s_waitcnt lgkmcnt(5)
  v_mfma_f32_32x32x16_bf16 v[32:47], v[112:115], v[76:79], v[32:47]
  ds_read_b64_tr_b16 v[100:101], v6 offset:64
  ds_read_b64_tr_b16 v[102:103], v6 offset:832
  s_waitcnt lgkmcnt(5)
  v_mfma_f32_32x32x16_bf16 v[48:63], v[116:119], v[76:79], v[48:63]
  ds_read_b64_tr_b16 v[104:105], v6 offset:128
  ds_read_b64_tr_b16 v[106:107], v6 offset:896
  v_dot2_f32_bf16 v120, v64, v128, v120
  v_dot2_f32_bf16 v124, v64, v64, v124
  v_dot2_f32_bf16 v121, v65, v128, v121
  v_dot2_f32_bf16 v125, v65, v65, v125
  v_dot2_f32_bf16 v122, v66, v128, v122
  v_dot2_f32_bf16 v126, v66, v66, v126
  v_dot2_f32_bf16 v123, v67, v128, v123
  v_dot2_f32_bf16 v127, v67, v67, v127
  v_dot2_f32_bf16 v120, v68, v128, v120
  v_dot2_f32_bf16 v124, v68, v68, v124
  v_dot2_f32_bf16 v121, v69, v128, v121
  v_dot2_f32_bf16 v125, v69, v69, v125
  v_dot2_f32_bf16 v122, v70, v128, v122
  v_dot2_f32_bf16 v126, v70, v70, v126
  v_dot2_f32_bf16 v123, v71, v128, v123
  v_dot2_f32_bf16 v127, v71, v71, v127
  v_dot2_f32_bf16 v120, v72, v128, v120
  v_dot2_f32_bf16 v124, v72, v72, v124
  v_dot2_f32_bf16 v121, v73, v128, v121
  v_dot2_f32_bf16 v125, v73, v73, v125
  v_dot2_f32_bf16 v122, v74, v128, v122
  v_dot2_f32_bf16 v126, v74, v74, v126
  v_dot2_f32_bf16 v123, v75, v128, v123
  v_dot2_f32_bf16 v127, v75, v75, v127
  v_dot2_f32_bf16 v120, v76, v128, v120
  v_dot2_f32_bf16 v124, v76, v76, v124
  v_dot2_f32_bf16 v121, v77, v128, v121
  v_dot2_f32_bf16 v125, v77, v77, v125
  v_dot2_f32_bf16 v122, v78, v128, v122
  v_dot2_f32_bf16 v126, v78, v78, v126
  v_dot2_f32_bf16 v123, v79, v128, v123
  v_dot2_f32_bf16 v127, v79, v79, v127
  s_waitcnt lgkmcnt(4)
  v_mfma_f32_32x32x16_bf16 v[16:31], v[96:99], v[80:83], v[16:31]
  ds_read_b128 v[84:87], v3
  ds_read_b64_tr_b16 v[108:109], v6 offset:3072
  ds_read_b64_tr_b16 v[110:111], v6 offset:3840
  s_waitcnt lgkmcnt(5)
  v_mfma_f32_32x32x16_bf16 v[32:47], v[100:103], v[80:83], v[32:47]
  ds_read_b64_tr_b16 v[112:113], v6 offset:3136
  ds_read_b64_tr_b16 v[114:115], v6 offset:3904
  s_waitcnt lgkmcnt(5)
  v_mfma_f32_32x32x16_bf16 v[48:63], v[104:107], v[80:83], v[48:63]
  ds_read_b64_tr_b16 v[116:117], v6 offset:3200
  ds_read_b64_tr_b16 v[118:119], v6 offset:3968
  s_waitcnt lgkmcnt(4)
  v_mfma_f32_32x32x16_bf16 v[16:31], v[108:111], v[84:87], v[16:31]
  ds_read_b128 v[88:91], v4
  ds_read_b64_tr_b16 v[96:97], v6 offset:6144
  ds_read_b64_tr_b16 v[98:99], v6 offset:6912
  s_waitcnt lgkmcnt(5)
  v_mfma_f32_32x32x16_bf16 v[32:47], v[112:115], v[84:87], v[32:47]
  ds_read_b64_tr_b16 v[100:101], v6 offset:6208
  ds_read_b64_tr_b16 v[102:103], v6 offset:6976
  s_waitcnt lgkmcnt(5)
  v_mfma_f32_32x32x16_bf16 v[48:63], v[116:119], v[84:87], v[48:63]
  ds_read_b64_tr_b16 v[104:105], v6 offset:6272
  ds_read_b64_tr_b16 v[106:107], v6 offset:7040
  s_waitcnt lgkmcnt(4)
  v_mfma_f32_32x32x16_bf16 v[16:31], v[96:99], v[88:91], v[16:31]
  ds_read_b128 v[92:95], v5
  ds_read_b64_tr_b16 v[108:109], v6 offset:9216
  ds_read_b64_tr_b16 v[110:111], v6 offset:9984
  s_waitcnt lgkmcnt(5)
  v_mfma_f32_32x32x16_bf16 v[32:47], v[100:103], v[88:91], v[32:47]
  ds_read_b64_tr_b16 v[112:113], v6 offset:9280
  ds_read_b64_tr_b16 v[114:115], v6 offset:10048
  s_waitcnt lgkmcnt(5)
  v_mfma_f32_32x32x16_bf16 v[48:63], v[104:107], v[88:91], v[48:63]
  ds_read_b64_tr_b16 v[116:117], v6 offset:9344
  ds_read_b64_tr_b16 v[118:119], v6 offset:10112
  s_waitcnt lgkmcnt(4)
  v_mfma_f32_32x32x16_bf16 v[16:31], v[108:111], v[92:95], v[16:31]
  s_waitcnt lgkmcnt(2)
  v_mfma_f32_32x32x16_bf16 v[32:47], v[112:115], v[92:95], v[32:47]
  s_waitcnt lgkmcnt(0)
  v_mfma_f32_32x32x16_bf16 v[48:63], v[116:119], v[92:95], v[48:63]
  s_branch sequential_preLN__mha_block__dense_activation_squared_relu__prompt_kernel_ave_6
sequential_preLN__mha_block__dense_activation_squared_relu__prompt_kernel_av1_4:
  s_mov_b32 s55, 0
  .p2align 3
sequential_preLN__mha_block__dense_activation_squared_relu__prompt_kernel_al_10:
  s_waitcnt lgkmcnt(4)
  v_mfma_f32_32x32x16_bf16 v[16:31], v[96:99], v[64:67], v[16:31]
  ds_read_b128 v[68:71], v3
  ds_read_b64_tr_b16 v[108:109], v6 offset:3072
  ds_read_b64_tr_b16 v[110:111], v6 offset:3840
  s_waitcnt lgkmcnt(5)
  v_mfma_f32_32x32x16_bf16 v[32:47], v[100:103], v[64:67], v[32:47]
  ds_read_b64_tr_b16 v[112:113], v6 offset:3136
  ds_read_b64_tr_b16 v[114:115], v6 offset:3904
  s_waitcnt lgkmcnt(5)
  v_mfma_f32_32x32x16_bf16 v[48:63], v[64:67], v[104:107], v[48:63]
  ds_read_b64_tr_b16 v[116:117], v6 offset:3200
  ds_read_b64_tr_b16 v[118:119], v6 offset:3968
  s_waitcnt lgkmcnt(4)
  v_mfma_f32_32x32x16_bf16 v[16:31], v[108:111], v[68:71], v[16:31]
  ds_read_b128 v[72:75], v4
  ds_read_b64_tr_b16 v[96:97], v6 offset:6144
  ds_read_b64_tr_b16 v[98:99], v6 offset:6912
  s_waitcnt lgkmcnt(5)
  v_mfma_f32_32x32x16_bf16 v[32:47], v[112:115], v[68:71], v[32:47]
  ds_read_b64_tr_b16 v[100:101], v6 offset:6208
  ds_read_b64_tr_b16 v[102:103], v6 offset:6976
  s_waitcnt lgkmcnt(5)
  v_mfma_f32_32x32x16_bf16 v[48:63], v[68:71], v[116:119], v[48:63]
  ds_read_b64_tr_b16 v[104:105], v6 offset:6272
  ds_read_b64_tr_b16 v[106:107], v6 offset:7040
  s_waitcnt lgkmcnt(4)
  v_mfma_f32_32x32x16_bf16 v[16:31], v[96:99], v[72:75], v[16:31]
  ds_read_b128 v[76:79], v5
  ds_read_b64_tr_b16 v[108:109], v6 offset:9216
  ds_read_b64_tr_b16 v[110:111], v6 offset:9984
  s_waitcnt lgkmcnt(5)
  v_mfma_f32_32x32x16_bf16 v[32:47], v[100:103], v[72:75], v[32:47]
  ds_read_b64_tr_b16 v[112:113], v6 offset:9280
  ds_read_b64_tr_b16 v[114:115], v6 offset:10048
  s_waitcnt lgkmcnt(5)
  v_mfma_f32_32x32x16_bf16 v[48:63], v[72:75], v[104:107], v[48:63]
  ds_read_b64_tr_b16 v[116:117], v6 offset:9344
  ds_read_b64_tr_b16 v[118:119], v6 offset:10112
  s_add_u32 s52, s52, 1
  s_cmp_eq_u32 s52, 5
  s_cselect_b32 s51, s54, s53
  s_cselect_b32 s52, 0, s52
  v_add_u32 v2, s51, v2
  v_add_u32 v3, s51, v3
  v_add_u32 v4, s51, v4
  v_add_u32 v5, s51, v5
  v_add_u32 v6, s51, v6
  s_waitcnt lgkmcnt(4)
  v_mfma_f32_32x32x16_bf16 v[16:31], v[108:111], v[76:79], v[16:31]
  s_barrier
  ds_read_b128 v[80:83], v2
  ds_read_b64_tr_b16 v[96:97], v6 offset:0
  ds_read_b64_tr_b16 v[98:99], v6 offset:768
  s_waitcnt lgkmcnt(5)
  v_mfma_f32_32x32x16_bf16 v[32:47], v[112:115], v[76:79], v[32:47]
  ds_read_b64_tr_b16 v[100:101], v6 offset:64
  ds_read_b64_tr_b16 v[102:103], v6 offset:832
  s_waitcnt lgkmcnt(5)
  v_mfma_f32_32x32x16_bf16 v[48:63], v[76:79], v[116:119], v[48:63]
  ds_read_b64_tr_b16 v[104:105], v6 offset:128
  ds_read_b64_tr_b16 v[106:107], v6 offset:896
  v_dot2_f32_bf16 v120, v64, v128, v120
  v_dot2_f32_bf16 v124, v64, v64, v124
  v_dot2_f32_bf16 v121, v65, v128, v121
  v_dot2_f32_bf16 v125, v65, v65, v125
  v_dot2_f32_bf16 v122, v66, v128, v122
  v_dot2_f32_bf16 v126, v66, v66, v126
  v_dot2_f32_bf16 v123, v67, v128, v123
  v_dot2_f32_bf16 v127, v67, v67, v127
  v_dot2_f32_bf16 v120, v68, v128, v120
  v_dot2_f32_bf16 v124, v68, v68, v124
  v_dot2_f32_bf16 v121, v69, v128, v121
  v_dot2_f32_bf16 v125, v69, v69, v125
  v_dot2_f32_bf16 v122, v70, v128, v122
  v_dot2_f32_bf16 v126, v70, v70, v126
  v_dot2_f32_bf16 v123, v71, v128, v123
  v_dot2_f32_bf16 v127, v71, v71, v127
  v_dot2_f32_bf16 v120, v72, v128, v120
  v_dot2_f32_bf16 v124, v72, v72, v124
  v_dot2_f32_bf16 v121, v73, v128, v121
  v_dot2_f32_bf16 v125, v73, v73, v125
  v_dot2_f32_bf16 v122, v74, v128, v122
  v_dot2_f32_bf16 v126, v74, v74, v126
  v_dot2_f32_bf16 v123, v75, v128, v123
  v_dot2_f32_bf16 v127, v75, v75, v127
  v_dot2_f32_bf16 v120, v76, v128, v120
  v_dot2_f32_bf16 v124, v76, v76, v124
  v_dot2_f32_bf16 v121, v77, v128, v121
  v_dot2_f32_bf16 v125, v77, v77, v125
  v_dot2_f32_bf16 v122, v78, v128, v122
  v_dot2_f32_bf16 v126, v78, v78, v126
  v_dot2_f32_bf16 v123, v79, v128, v123
  v_dot2_f32_bf16 v127, v79, v79, v127
  s_cmp_eq_u32 s55, 2
  s_cbranch_scc0 sequential_preLN__mha_block__dense_activation_squared_relu__prompt_kernel_nn2_11
  s_cmp_lg_u32 s3, 0
  s_cbranch_scc1 sequential_preLN__mha_block__dense_activation_squared_relu__prompt_kernel_nw0_12
  v_mov_b32 v149, 0
  buffer_load_dword v148, v149, s[20:23], 0 offen sc1
sequential_preLN__mha_block__dense_activation_squared_relu__prompt_kernel_nw0_12:
sequential_preLN__mha_block__dense_activation_squared_relu__prompt_kernel_nn2_11:
  s_waitcnt lgkmcnt(4)
  v_mfma_f32_32x32x16_bf16 v[16:31], v[96:99], v[80:83], v[16:31]
  ds_read_b128 v[84:87], v3
  ds_read_b64_tr_b16 v[108:109], v6 offset:3072
  ds_read_b64_tr_b16 v[110:111], v6 offset:3840
  s_waitcnt lgkmcnt(5)
  v_mfma_f32_32x32x16_bf16 v[32:47], v[100:103], v[80:83], v[32:47]
  ds_read_b64_tr_b16 v[112:113], v6 offset:3136
  ds_read_b64_tr_b16 v[114:115], v6 offset:3904
  s_waitcnt lgkmcnt(5)
  v_mfma_f32_32x32x16_bf16 v[48:63], v[80:83], v[104:107], v[48:63]
  ds_read_b64_tr_b16 v[116:117], v6 offset:3200
  ds_read_b64_tr_b16 v[118:119], v6 offset:3968
  s_waitcnt lgkmcnt(4)
  v_mfma_f32_32x32x16_bf16 v[16:31], v[108:111], v[84:87], v[16:31]
  ds_read_b128 v[88:91], v4
  ds_read_b64_tr_b16 v[96:97], v6 offset:6144
  ds_read_b64_tr_b16 v[98:99], v6 offset:6912
  s_waitcnt lgkmcnt(5)
  v_mfma_f32_32x32x16_bf16 v[32:47], v[112:115], v[84:87], v[32:47]
  ds_read_b64_tr_b16 v[100:101], v6 offset:6208
  ds_read_b64_tr_b16 v[102:103], v6 offset:6976
  s_waitcnt lgkmcnt(5)
  v_mfma_f32_32x32x16_bf16 v[48:63], v[84:87], v[116:119], v[48:63]
  ds_read_b64_tr_b16 v[104:105], v6 offset:6272
  ds_read_b64_tr_b16 v[106:107], v6 offset:7040
  s_waitcnt lgkmcnt(4)
  v_mfma_f32_32x32x16_bf16 v[16:31], v[96:99], v[88:91], v[16:31]
  ds_read_b128 v[92:95], v5
  ds_read_b64_tr_b16 v[108:109], v6 offset:9216
  ds_read_b64_tr_b16 v[110:111], v6 offset:9984
  s_waitcnt lgkmcnt(5)
  v_mfma_f32_32x32x16_bf16 v[32:47], v[100:103], v[88:91], v[32:47]
  ds_read_b64_tr_b16 v[112:113], v6 offset:9280
  ds_read_b64_tr_b16 v[114:115], v6 offset:10048
  s_waitcnt lgkmcnt(5)
  v_mfma_f32_32x32x16_bf16 v[48:63], v[88:91], v[104:107], v[48:63]
  ds_read_b64_tr_b16 v[116:117], v6 offset:9344
  ds_read_b64_tr_b16 v[118:119], v6 offset:10112
  s_add_u32 s52, s52, 1
  s_cmp_eq_u32 s52, 5
  s_cselect_b32 s51, s54, s53
  s_cselect_b32 s52, 0, s52
  v_add_u32 v2, s51, v2
  v_add_u32 v3, s51, v3
  v_add_u32 v4, s51, v4
  v_add_u32 v5, s51, v5
  v_add_u32 v6, s51, v6
  s_waitcnt lgkmcnt(4)
  v_mfma_f32_32x32x16_bf16 v[16:31], v[108:111], v[92:95], v[16:31]
  s_barrier
  ds_read_b128 v[64:67], v2
  ds_read_b64_tr_b16 v[96:97], v6 offset:0
  ds_read_b64_tr_b16 v[98:99], v6 offset:768
  s_waitcnt lgkmcnt(5)
  v_mfma_f32_32x32x16_bf16 v[32:47], v[112:115], v[92:95], v[32:47]
  ds_read_b64_tr_b16 v[100:101], v6 offset:64
  ds_read_b64_tr_b16 v[102:103], v6 offset:832
  s_waitcnt lgkmcnt(5)
  v_mfma_f32_32x32x16_bf16 v[48:63], v[92:95], v[116:119], v[48:63]
  ds_read_b64_tr_b16 v[104:105], v6 offset:128
  ds_read_b64_tr_b16 v[106:107], v6 offset:896
  v_dot2_f32_bf16 v120, v80, v128, v120
  v_dot2_f32_bf16 v124, v80, v80, v124
  v_dot2_f32_bf16 v121, v81, v128, v121
  v_dot2_f32_bf16 v125, v81, v81, v125
  v_dot2_f32_bf16 v122, v82, v128, v122
  v_dot2_f32_bf16 v126, v82, v82, v126
  v_dot2_f32_bf16 v123, v83, v128, v123
  v_dot2_f32_bf16 v127, v83, v83, v127
  v_dot2_f32_bf16 v120, v84, v128, v120
  v_dot2_f32_bf16 v124, v84, v84, v124
  v_dot2_f32_bf16 v121, v85, v128, v121
  v_dot2_f32_bf16 v125, v85, v85, v125
  v_dot2_f32_bf16 v122, v86, v128, v122
  v_dot2_f32_bf16 v126, v86, v86, v126
  v_dot2_f32_bf16 v123, v87, v128, v123
  v_dot2_f32_bf16 v127, v87, v87, v127
  v_dot2_f32_bf16 v120, v88, v128, v120
  v_dot2_f32_bf16 v124, v88, v88, v124
  v_dot2_f32_bf16 v121, v89, v128, v121
  v_dot2_f32_bf16 v125, v89, v89, v125
  v_dot2_f32_bf16 v122, v90, v128, v122
  v_dot2_f32_bf16 v126, v90, v90, v126
  v_dot2_f32_bf16 v123, v91, v128, v123
  v_dot2_f32_bf16 v127, v91, v91, v127
  v_dot2_f32_bf16 v120, v92, v128, v120
  v_dot2_f32_bf16 v124, v92, v92, v124
  v_dot2_f32_bf16 v121, v93, v128, v121
  v_dot2_f32_bf16 v125, v93, v93, v125
  v_dot2_f32_bf16 v122, v94, v128, v122
  v_dot2_f32_bf16 v126, v94, v94, v126
  v_dot2_f32_bf16 v123, v95, v128, v123
  v_dot2_f32_bf16 v127, v95, v95, v127
  s_add_u32 s55, s55, 1
  s_cmp_lt_u32 s55, 3
  s_cbranch_scc1 sequential_preLN__mha_block__dense_activation_squared_relu__prompt_kernel_al_10
  s_waitcnt lgkmcnt(4)
  v_mfma_f32_32x32x16_bf16 v[16:31], v[96:99], v[64:67], v[16:31]
  ds_read_b128 v[68:71], v3
  ds_read_b64_tr_b16 v[108:109], v6 offset:3072
  ds_read_b64_tr_b16 v[110:111], v6 offset:3840
  s_waitcnt lgkmcnt(5)
  v_mfma_f32_32x32x16_bf16 v[32:47], v[100:103], v[64:67], v[32:47]
  ds_read_b64_tr_b16 v[112:113], v6 offset:3136
  ds_read_b64_tr_b16 v[114:115], v6 offset:3904
  s_waitcnt lgkmcnt(5)
  v_mfma_f32_32x32x16_bf16 v[48:63], v[64:67], v[104:107], v[48:63]
  ds_read_b64_tr_b16 v[116:117], v6 offset:3200
  ds_read_b64_tr_b16 v[118:119], v6 offset:3968
  s_waitcnt lgkmcnt(4)
  v_mfma_f32_32x32x16_bf16 v[16:31], v[108:111], v[68:71], v[16:31]
  ds_read_b128 v[72:75], v4
  ds_read_b64_tr_b16 v[96:97], v6 offset:6144
  ds_read_b64_tr_b16 v[98:99], v6 offset:6912
  s_waitcnt lgkmcnt(5)
  v_mfma_f32_32x32x16_bf16 v[32:47], v[112:115], v[68:71], v[32:47]
  ds_read_b64_tr_b16 v[100:101], v6 offset:6208
  ds_read_b64_tr_b16 v[102:103], v6 offset:6976
  s_waitcnt lgkmcnt(5)
  v_mfma_f32_32x32x16_bf16 v[48:63], v[68:71], v[116:119], v[48:63]
  ds_read_b64_tr_b16 v[104:105], v6 offset:6272
  ds_read_b64_tr_b16 v[106:107], v6 offset:7040
  s_waitcnt lgkmcnt(4)
  v_mfma_f32_32x32x16_bf16 v[16:31], v[96:99], v[72:75], v[16:31]
  ds_read_b128 v[76:79], v5
  ds_read_b64_tr_b16 v[108:109], v6 offset:9216
  ds_read_b64_tr_b16 v[110:111], v6 offset:9984
  s_waitcnt lgkmcnt(5)
  v_mfma_f32_32x32x16_bf16 v[32:47], v[100:103], v[72:75], v[32:47]
  ds_read_b64_tr_b16 v[112:113], v6 offset:9280
  ds_read_b64_tr_b16 v[114:115], v6 offset:10048
  s_waitcnt lgkmcnt(5)
  v_mfma_f32_32x32x16_bf16 v[48:63], v[72:75], v[104:107], v[48:63]
  ds_read_b64_tr_b16 v[116:117], v6 offset:9344
  ds_read_b64_tr_b16 v[118:119], v6 offset:10112
  s_add_u32 s52, s52, 1
  s_cmp_eq_u32 s52, 5
  s_cselect_b32 s51, s54, s53
  s_cselect_b32 s52, 0, s52
  v_add_u32 v2, s51, v2
  v_add_u32 v3, s51, v3
  v_add_u32 v4, s51, v4
  v_add_u32 v5, s51, v5
  v_add_u32 v6, s51, v6
  s_waitcnt lgkmcnt(4)
  v_mfma_f32_32x32x16_bf16 v[16:31], v[108:111], v[76:79], v[16:31]
  s_barrier
  ds_read_b128 v[80:83], v2
  ds_read_b64_tr_b16 v[96:97], v6 offset:0
  ds_read_b64_tr_b16 v[98:99], v6 offset:768
  s_waitcnt lgkmcnt(5)
  v_mfma_f32_32x32x16_bf16 v[32:47], v[112:115], v[76:79], v[32:47]
  ds_read_b64_tr_b16 v[100:101], v6 offset:64
  ds_read_b64_tr_b16 v[102:103], v6 offset:832
  s_waitcnt lgkmcnt(5)
  v_mfma_f32_32x32x16_bf16 v[48:63], v[76:79], v[116:119], v[48:63]
  ds_read_b64_tr_b16 v[104:105], v6 offset:128
  ds_read_b64_tr_b16 v[106:107], v6 offset:896
  v_dot2_f32_bf16 v120, v64, v128, v120
  v_dot2_f32_bf16 v124, v64, v64, v124
  v_dot2_f32_bf16 v121, v65, v128, v121
  v_dot2_f32_bf16 v125, v65, v65, v125
  v_dot2_f32_bf16 v122, v66, v128, v122
  v_dot2_f32_bf16 v126, v66, v66, v126
  v_dot2_f32_bf16 v123, v67, v128, v123
  v_dot2_f32_bf16 v127, v67, v67, v127
  v_dot2_f32_bf16 v120, v68, v128, v120
  v_dot2_f32_bf16 v124, v68, v68, v124
  v_dot2_f32_bf16 v121, v69, v128, v121
  v_dot2_f32_bf16 v125, v69, v69, v125
  v_dot2_f32_bf16 v122, v70, v128, v122
  v_dot2_f32_bf16 v126, v70, v70, v126
  v_dot2_f32_bf16 v123, v71, v128, v123
  v_dot2_f32_bf16 v127, v71, v71, v127
  v_dot2_f32_bf16 v120, v72, v128, v120
  v_dot2_f32_bf16 v124, v72, v72, v124
  v_dot2_f32_bf16 v121, v73, v128, v121
  v_dot2_f32_bf16 v125, v73, v73, v125
  v_dot2_f32_bf16 v122, v74, v128, v122
  v_dot2_f32_bf16 v126, v74, v74, v126
  v_dot2_f32_bf16 v123, v75, v128, v123
  v_dot2_f32_bf16 v127, v75, v75, v127
  v_dot2_f32_bf16 v120, v76, v128, v120
  v_dot2_f32_bf16 v124, v76, v76, v124
  v_dot2_f32_bf16 v121, v77, v128, v121
  v_dot2_f32_bf16 v125, v77, v77, v125
  v_dot2_f32_bf16 v122, v78, v128, v122
  v_dot2_f32_bf16 v126, v78, v78, v126
  v_dot2_f32_bf16 v123, v79, v128, v123
  v_dot2_f32_bf16 v127, v79, v79, v127
  s_waitcnt lgkmcnt(4)
  v_mfma_f32_32x32x16_bf16 v[16:31], v[96:99], v[80:83], v[16:31]
  ds_read_b128 v[84:87], v3
  ds_read_b64_tr_b16 v[108:109], v6 offset:3072
  ds_read_b64_tr_b16 v[110:111], v6 offset:3840
  s_waitcnt lgkmcnt(5)
  v_mfma_f32_32x32x16_bf16 v[32:47], v[100:103], v[80:83], v[32:47]
  ds_read_b64_tr_b16 v[112:113], v6 offset:3136
  ds_read_b64_tr_b16 v[114:115], v6 offset:3904
  s_waitcnt lgkmcnt(5)
  v_mfma_f32_32x32x16_bf16 v[48:63], v[80:83], v[104:107], v[48:63]
  ds_read_b64_tr_b16 v[116:117], v6 offset:3200
  ds_read_b64_tr_b16 v[118:119], v6 offset:3968
  s_waitcnt lgkmcnt(4)
  v_mfma_f32_32x32x16_bf16 v[16:31], v[108:111], v[84:87], v[16:31]
  ds_read_b128 v[88:91], v4
  ds_read_b64_tr_b16 v[96:97], v6 offset:6144
  ds_read_b64_tr_b16 v[98:99], v6 offset:6912
  s_waitcnt lgkmcnt(5)
  v_mfma_f32_32x32x16_bf16 v[32:47], v[112:115], v[84:87], v[32:47]
  ds_read_b64_tr_b16 v[100:101], v6 offset:6208
  ds_read_b64_tr_b16 v[102:103], v6 offset:6976
  s_waitcnt lgkmcnt(5)
  v_mfma_f32_32x32x16_bf16 v[48:63], v[84:87], v[116:119], v[48:63]
  ds_read_b64_tr_b16 v[104:105], v6 offset:6272
  ds_read_b64_tr_b16 v[106:107], v6 offset:7040
  s_waitcnt lgkmcnt(4)
  v_mfma_f32_32x32x16_bf16 v[16:31], v[96:99], v[88:91], v[16:31]
  ds_read_b128 v[92:95], v5
  ds_read_b64_tr_b16 v[108:109], v6 offset:9216
  ds_read_b64_tr_b16 v[110:111], v6 offset:9984
  s_waitcnt lgkmcnt(5)
  v_mfma_f32_32x32x16_bf16 v[32:47], v[100:103], v[88:91], v[32:47]
  ds_read_b64_tr_b16 v[112:113], v6 offset:9280
  ds_read_b64_tr_b16 v[114:115], v6 offset:10048
  s_waitcnt lgkmcnt(5)
  v_mfma_f32_32x32x16_bf16 v[48:63], v[88:91], v[104:107], v[48:63]
  ds_read_b64_tr_b16 v[116:117], v6 offset:9344
  ds_read_b64_tr_b16 v[118:119], v6 offset:10112
  s_waitcnt lgkmcnt(4)
  v_mfma_f32_32x32x16_bf16 v[16:31], v[108:111], v[92:95], v[16:31]
  s_waitcnt lgkmcnt(2)
  v_mfma_f32_32x32x16_bf16 v[32:47], v[112:115], v[92:95], v[32:47]
  s_waitcnt lgkmcnt(0)
  v_mfma_f32_32x32x16_bf16 v[48:63], v[92:95], v[116:119], v[48:63]
  s_branch sequential_preLN__mha_block__dense_activation_squared_relu__prompt_kernel_ave_6
sequential_preLN__mha_block__dense_activation_squared_relu__prompt_kernel_av2_5:
  s_mov_b32 s55, 0
  .p2align 3
sequential_preLN__mha_block__dense_activation_squared_relu__prompt_kernel_al_13:
  s_waitcnt lgkmcnt(4)
  v_mfma_f32_32x32x16_bf16 v[16:31], v[64:67], v[96:99], v[16:31]
  ds_read_b128 v[68:71], v3
  ds_read_b64_tr_b16 v[108:109], v6 offset:3072
  ds_read_b64_tr_b16 v[110:111], v6 offset:3840
  s_waitcnt lgkmcnt(5)
  v_mfma_f32_32x32x16_bf16 v[32:47], v[64:67], v[100:103], v[32:47]
  ds_read_b64_tr_b16 v[112:113], v6 offset:3136
  ds_read_b64_tr_b16 v[114:115], v6 offset:3904
  s_waitcnt lgkmcnt(5)
  v_mfma_f32_32x32x16_bf16 v[48:63], v[64:67], v[104:107], v[48:63]
  ds_read_b64_tr_b16 v[116:117], v6 offset:3200
  ds_read_b64_tr_b16 v[118:119], v6 offset:3968
  s_waitcnt lgkmcnt(4)
  v_mfma_f32_32x32x16_bf16 v[16:31], v[68:71], v[108:111], v[16:31]
  ds_read_b128 v[72:75], v4
  ds_read_b64_tr_b16 v[96:97], v6 offset:6144
  ds_read_b64_tr_b16 v[98:99], v6 offset:6912
  s_waitcnt lgkmcnt(5)
  v_mfma_f32_32x32x16_bf16 v[32:47], v[68:71], v[112:115], v[32:47]
  ds_read_b64_tr_b16 v[100:101], v6 offset:6208
  ds_read_b64_tr_b16 v[102:103], v6 offset:6976
  s_waitcnt lgkmcnt(5)
  v_mfma_f32_32x32x16_bf16 v[48:63], v[68:71], v[116:119], v[48:63]
  ds_read_b64_tr_b16 v[104:105], v6 offset:6272
  ds_read_b64_tr_b16 v[106:107], v6 offset:7040
  s_waitcnt lgkmcnt(4)
  v_mfma_f32_32x32x16_bf16 v[16:31], v[72:75], v[96:99], v[16:31]
  ds_read_b128 v[76:79], v5
  ds_read_b64_tr_b16 v[108:109], v6 offset:9216
  ds_read_b64_tr_b16 v[110:111], v6 offset:9984
  s_waitcnt lgkmcnt(5)
  v_mfma_f32_32x32x16_bf16 v[32:47], v[72:75], v[100:103], v[32:47]
  ds_read_b64_tr_b16 v[112:113], v6 offset:9280
  ds_read_b64_tr_b16 v[114:115], v6 offset:10048
  s_waitcnt lgkmcnt(5)
  v_mfma_f32_32x32x16_bf16 v[48:63], v[72:75], v[104:107], v[48:63]
  ds_read_b64_tr_b16 v[116:117], v6 offset:9344
  ds_read_b64_tr_b16 v[118:119], v6 offset:10112
  s_add_u32 s52, s52, 1
  s_cmp_eq_u32 s52, 5
  s_cselect_b32 s51, s54, s53
  s_cselect_b32 s52, 0, s52
  v_add_u32 v2, s51, v2
  v_add_u32 v3, s51, v3
  v_add_u32 v4, s51, v4
  v_add_u32 v5, s51, v5
  v_add_u32 v6, s51, v6
  s_waitcnt lgkmcnt(4)
  v_mfma_f32_32x32x16_bf16 v[16:31], v[76:79], v[108:111], v[16:31]
  s_barrier
  ds_read_b128 v[80:83], v2
  ds_read_b64_tr_b16 v[96:97], v6 offset:0
  ds_read_b64_tr_b16 v[98:99], v6 offset:768
  s_waitcnt lgkmcnt(5)
  v_mfma_f32_32x32x16_bf16 v[32:47], v[76:79], v[112:115], v[32:47]
  ds_read_b64_tr_b16 v[100:101], v6 offset:64
  ds_read_b64_tr_b16 v[102:103], v6 offset:832
  s_waitcnt lgkmcnt(5)
  v_mfma_f32_32x32x16_bf16 v[48:63], v[76:79], v[116:119], v[48:63]
  ds_read_b64_tr_b16 v[104:105], v6 offset:128
  ds_read_b64_tr_b16 v[106:107], v6 offset:896
  v_dot2_f32_bf16 v120, v64, v128, v120
  v_dot2_f32_bf16 v124, v64, v64, v124
  v_dot2_f32_bf16 v121, v65, v128, v121
  v_dot2_f32_bf16 v125, v65, v65, v125
  v_dot2_f32_bf16 v122, v66, v128, v122
  v_dot2_f32_bf16 v126, v66, v66, v126
  v_dot2_f32_bf16 v123, v67, v128, v123
  v_dot2_f32_bf16 v127, v67, v67, v127
  v_dot2_f32_bf16 v120, v68, v128, v120
  v_dot2_f32_bf16 v124, v68, v68, v124
  v_dot2_f32_bf16 v121, v69, v128, v121
  v_dot2_f32_bf16 v125, v69, v69, v125
  v_dot2_f32_bf16 v122, v70, v128, v122
  v_dot2_f32_bf16 v126, v70, v70, v126
  v_dot2_f32_bf16 v123, v71, v128, v123
  v_dot2_f32_bf16 v127, v71, v71, v127
  v_dot2_f32_bf16 v120, v72, v128, v120
  v_dot2_f32_bf16 v124, v72, v72, v124
  v_dot2_f32_bf16 v121, v73, v128, v121
  v_dot2_f32_bf16 v125, v73, v73, v125
  v_dot2_f32_bf16 v122, v74, v128, v122
  v_dot2_f32_bf16 v126, v74, v74, v126
  v_dot2_f32_bf16 v123, v75, v128, v123
  v_dot2_f32_bf16 v127, v75, v75, v127
  v_dot2_f32_bf16 v120, v76, v128, v120
  v_dot2_f32_bf16 v124, v76, v76, v124
  v_dot2_f32_bf16 v121, v77, v128, v121
  v_dot2_f32_bf16 v125, v77, v77, v125
  v_dot2_f32_bf16 v122, v78, v128, v122
  v_dot2_f32_bf16 v126, v78, v78, v126
  v_dot2_f32_bf16 v123, v79, v128, v123
  v_dot2_f32_bf16 v127, v79, v79, v127
  s_cmp_eq_u32 s55, 2
  s_cbranch_scc0 sequential_preLN__mha_block__dense_activation_squared_relu__prompt_kernel_nn2_14
  s_cmp_lg_u32 s3, 0
  s_cbranch_scc1 sequential_preLN__mha_block__dense_activation_squared_relu__prompt_kernel_nw0_15
  v_mov_b32 v149, 0
  buffer_load_dword v148, v149, s[20:23], 0 offen sc1
sequential_preLN__mha_block__dense_activation_squared_relu__prompt_kernel_nw0_15:
sequential_preLN__mha_block__dense_activation_squared_relu__prompt_kernel_nn2_14:
  s_waitcnt lgkmcnt(4)
  v_mfma_f32_32x32x16_bf16 v[16:31], v[80:83], v[96:99], v[16:31]
  ds_read_b128 v[84:87], v3
  ds_read_b64_tr_b16 v[108:109], v6 offset:3072
  ds_read_b64_tr_b16 v[110:111], v6 offset:3840
  s_waitcnt lgkmcnt(5)
  v_mfma_f32_32x32x16_bf16 v[32:47], v[80:83], v[100:103], v[32:47]
  ds_read_b64_tr_b16 v[112:113], v6 offset:3136
  ds_read_b64_tr_b16 v[114:115], v6 offset:3904
  s_waitcnt lgkmcnt(5)
  v_mfma_f32_32x32x16_bf16 v[48:63], v[80:83], v[104:107], v[48:63]
  ds_read_b64_tr_b16 v[116:117], v6 offset:3200
  ds_read_b64_tr_b16 v[118:119], v6 offset:3968
  s_waitcnt lgkmcnt(4)
  v_mfma_f32_32x32x16_bf16 v[16:31], v[84:87], v[108:111], v[16:31]
  ds_read_b128 v[88:91], v4
  ds_read_b64_tr_b16 v[96:97], v6 offset:6144
  ds_read_b64_tr_b16 v[98:99], v6 offset:6912
  s_waitcnt lgkmcnt(5)
  v_mfma_f32_32x32x16_bf16 v[32:47], v[84:87], v[112:115], v[32:47]
  ds_read_b64_tr_b16 v[100:101], v6 offset:6208
  ds_read_b64_tr_b16 v[102:103], v6 offset:6976
  s_waitcnt lgkmcnt(5)
  v_mfma_f32_32x32x16_bf16 v[48:63], v[84:87], v[116:119], v[48:63]
  ds_read_b64_tr_b16 v[104:105], v6 offset:6272
  ds_read_b64_tr_b16 v[106:107], v6 offset:7040
  s_waitcnt lgkmcnt(4)
  v_mfma_f32_32x32x16_bf16 v[16:31], v[88:91], v[96:99], v[16:31]
  ds_read_b128 v[92:95], v5
  ds_read_b64_tr_b16 v[108:109], v6 offset:9216
  ds_read_b64_tr_b16 v[110:111], v6 offset:9984
  s_waitcnt lgkmcnt(5)
  v_mfma_f32_32x32x16_bf16 v[32:47], v[88:91], v[100:103], v[32:47]
  ds_read_b64_tr_b16 v[112:113], v6 offset:9280
  ds_read_b64_tr_b16 v[114:115], v6 offset:10048
  s_waitcnt lgkmcnt(5)
  v_mfma_f32_32x32x16_bf16 v[48:63], v[88:91], v[104:107], v[48:63]
  ds_read_b64_tr_b16 v[116:117], v6 offset:9344
  ds_read_b64_tr_b16 v[118:119], v6 offset:10112
  s_add_u32 s52, s52, 1
  s_cmp_eq_u32 s52, 5
  s_cselect_b32 s51, s54, s53
  s_cselect_b32 s52, 0, s52
  v_add_u32 v2, s51, v2
  v_add_u32 v3, s51, v3
  v_add_u32 v4, s51, v4
  v_add_u32 v5, s51, v5
  v_add_u32 v6, s51, v6
  s_waitcnt lgkmcnt(4)
  v_mfma_f32_32x32x16_bf16 v[16:31], v[92:95], v[108:111], v[16:31]
  s_barrier
  ds_read_b128 v[64:67], v2
  ds_read_b64_tr_b16 v[96:97], v6 offset:0
  ds_read_b64_tr_b16 v[98:99], v6 offset:768
  s_waitcnt lgkmcnt(5)
  v_mfma_f32_32x32x16_bf16 v[32:47], v[92:95], v[112:115], v[32:47]
  ds_read_b64_tr_b16 v[100:101], v6 offset:64
  ds_read_b64_tr_b16 v[102:103], v6 offset:832
  s_waitcnt lgkmcnt(5)
  v_mfma_f32_32x32x16_bf16 v[48:63], v[92:95], v[116:119], v[48:63]
  ds_read_b64_tr_b16 v[104:105], v6 offset:128
  ds_read_b64_tr_b16 v[106:107], v6 offset:896
  v_dot2_f32_bf16 v120, v80, v128, v120
  v_dot2_f32_bf16 v124, v80, v80, v124
  v_dot2_f32_bf16 v121, v81, v128, v121
  v_dot2_f32_bf16 v125, v81, v81, v125
  v_dot2_f32_bf16 v122, v82, v128, v122
  v_dot2_f32_bf16 v126, v82, v82, v126
  v_dot2_f32_bf16 v123, v83, v128, v123
  v_dot2_f32_bf16 v127, v83, v83, v127
  v_dot2_f32_bf16 v120, v84, v128, v120
  v_dot2_f32_bf16 v124, v84, v84, v124
  v_dot2_f32_bf16 v121, v85, v128, v121
  v_dot2_f32_bf16 v125, v85, v85, v125
  v_dot2_f32_bf16 v122, v86, v128, v122
  v_dot2_f32_bf16 v126, v86, v86, v126
  v_dot2_f32_bf16 v123, v87, v128, v123
  v_dot2_f32_bf16 v127, v87, v87, v127
  v_dot2_f32_bf16 v120, v88, v128, v120
  v_dot2_f32_bf16 v124, v88, v88, v124
  v_dot2_f32_bf16 v121, v89, v128, v121
  v_dot2_f32_bf16 v125, v89, v89, v125
  v_dot2_f32_bf16 v122, v90, v128, v122
  v_dot2_f32_bf16 v126, v90, v90, v126
  v_dot2_f32_bf16 v123, v91, v128, v123
  v_dot2_f32_bf16 v127, v91, v91, v127
  v_dot2_f32_bf16 v120, v92, v128, v120
  v_dot2_f32_bf16 v124, v92, v92, v124
  v_dot2_f32_bf16 v121, v93, v128, v121
  v_dot2_f32_bf16 v125, v93, v93, v125
  v_dot2_f32_bf16 v122, v94, v128, v122
  v_dot2_f32_bf16 v126, v94, v94, v126
  v_dot2_f32_bf16 v123, v95, v128, v123
  v_dot2_f32_bf16 v127, v95, v95, v127
  s_add_u32 s55, s55, 1
  s_cmp_lt_u32 s55, 3
  s_cbranch_scc1 sequential_preLN__mha_block__dense_activation_squared_relu__prompt_kernel_al_13
  s_waitcnt lgkmcnt(4)
  v_mfma_f32_32x32x16_bf16 v[16:31], v[64:67], v[96:99], v[16:31]
  ds_read_b128 v[68:71], v3
  ds_read_b64_tr_b16 v[108:109], v6 offset:3072
  ds_read_b64_tr_b16 v[110:111], v6 offset:3840
  s_waitcnt lgkmcnt(5)
  v_mfma_f32_32x32x16_bf16 v[32:47], v[64:67], v[100:103], v[32:47]
  ds_read_b64_tr_b16 v[112:113], v6 offset:3136
  ds_read_b64_tr_b16 v[114:115], v6 offset:3904
  s_waitcnt lgkmcnt(5)
  v_mfma_f32_32x32x16_bf16 v[48:63], v[64:67], v[104:107], v[48:63]
  ds_read_b64_tr_b16 v[116:117], v6 offset:3200
  ds_read_b64_tr_b16 v[118:119], v6 offset:3968
  s_waitcnt lgkmcnt(4)
  v_mfma_f32_32x32x16_bf16 v[16:31], v[68:71], v[108:111], v[16:31]
  ds_read_b128 v[72:75], v4
  ds_read_b64_tr_b16 v[96:97], v6 offset:6144
  ds_read_b64_tr_b16 v[98:99], v6 offset:6912
  s_waitcnt lgkmcnt(5)
  v_mfma_f32_32x32x16_bf16 v[32:47], v[68:71], v[112:115], v[32:47]
  ds_read_b64_tr_b16 v[100:101], v6 offset:6208
  ds_read_b64_tr_b16 v[102:103], v6 offset:6976
  s_waitcnt lgkmcnt(5)
  v_mfma_f32_32x32x16_bf16 v[48:63], v[68:71], v[116:119], v[48:63]
  ds_read_b64_tr_b16 v[104:105], v6 offset:6272
  ds_read_b64_tr_b16 v[106:107], v6 offset:7040
  s_waitcnt lgkmcnt(4)
  v_mfma_f32_32x32x16_bf16 v[16:31], v[72:75], v[96:99], v[16:31]
  ds_read_b128 v[76:79], v5
  ds_read_b64_tr_b16 v[108:109], v6 offset:9216
  ds_read_b64_tr_b16 v[110:111], v6 offset:9984
  s_waitcnt lgkmcnt(5)
  v_mfma_f32_32x32x16_bf16 v[32:47], v[72:75], v[100:103], v[32:47]
  ds_read_b64_tr_b16 v[112:113], v6 offset:9280
  ds_read_b64_tr_b16 v[114:115], v6 offset:10048
  s_waitcnt lgkmcnt(5)
  v_mfma_f32_32x32x16_bf16 v[48:63], v[72:75], v[104:107], v[48:63]
  ds_read_b64_tr_b16 v[116:117], v6 offset:9344
  ds_read_b64_tr_b16 v[118:119], v6 offset:10112
  s_add_u32 s52, s52, 1
  s_cmp_eq_u32 s52, 5
  s_cselect_b32 s51, s54, s53
  s_cselect_b32 s52, 0, s52
  v_add_u32 v2, s51, v2
  v_add_u32 v3, s51, v3
  v_add_u32 v4, s51, v4
  v_add_u32 v5, s51, v5
  v_add_u32 v6, s51, v6
  s_waitcnt lgkmcnt(4)
  v_mfma_f32_32x32x16_bf16 v[16:31], v[76:79], v[108:111], v[16:31]
  s_barrier
  ds_read_b128 v[80:83], v2
  ds_read_b64_tr_b16 v[96:97], v6 offset:0
  ds_read_b64_tr_b16 v[98:99], v6 offset:768
  s_waitcnt lgkmcnt(5)
  v_mfma_f32_32x32x16_bf16 v[32:47], v[76:79], v[112:115], v[32:47]
  ds_read_b64_tr_b16 v[100:101], v6 offset:64
  ds_read_b64_tr_b16 v[102:103], v6 offset:832
  s_waitcnt lgkmcnt(5)
  v_mfma_f32_32x32x16_bf16 v[48:63], v[76:79], v[116:119], v[48:63]
  ds_read_b64_tr_b16 v[104:105], v6 offset:128
  ds_read_b64_tr_b16 v[106:107], v6 offset:896
  v_dot2_f32_bf16 v120, v64, v128, v120
  v_dot2_f32_bf16 v124, v64, v64, v124
  v_dot2_f32_bf16 v121, v65, v128, v121
  v_dot2_f32_bf16 v125, v65, v65, v125
  v_dot2_f32_bf16 v122, v66, v128, v122
  v_dot2_f32_bf16 v126, v66, v66, v126
  v_dot2_f32_bf16 v123, v67, v128, v123
  v_dot2_f32_bf16 v127, v67, v67, v127
  v_dot2_f32_bf16 v120, v68, v128, v120
  v_dot2_f32_bf16 v124, v68, v68, v124
  v_dot2_f32_bf16 v121, v69, v128, v121
  v_dot2_f32_bf16 v125, v69, v69, v125
  v_dot2_f32_bf16 v122, v70, v128, v122
  v_dot2_f32_bf16 v126, v70, v70, v126
  v_dot2_f32_bf16 v123, v71, v128, v123
  v_dot2_f32_bf16 v127, v71, v71, v127
  v_dot2_f32_bf16 v120, v72, v128, v120
  v_dot2_f32_bf16 v124, v72, v72, v124
  v_dot2_f32_bf16 v121, v73, v128, v121
  v_dot2_f32_bf16 v125, v73, v73, v125
  v_dot2_f32_bf16 v122, v74, v128, v122
  v_dot2_f32_bf16 v126, v74, v74, v126
  v_dot2_f32_bf16 v123, v75, v128, v123
  v_dot2_f32_bf16 v127, v75, v75, v127
  v_dot2_f32_bf16 v120, v76, v128, v120
  v_dot2_f32_bf16 v124, v76, v76, v124
  v_dot2_f32_bf16 v121, v77, v128, v121
  v_dot2_f32_bf16 v125, v77, v77, v125
  v_dot2_f32_bf16 v122, v78, v128, v122
  v_dot2_f32_bf16 v126, v78, v78, v126
  v_dot2_f32_bf16 v123, v79, v128, v123
  v_dot2_f32_bf16 v127, v79, v79, v127
  s_waitcnt lgkmcnt(4)
  v_mfma_f32_32x32x16_bf16 v[16:31], v[80:83], v[96:99], v[16:31]
  ds_read_b128 v[84:87], v3
  ds_read_b64_tr_b16 v[108:109], v6 offset:3072
  ds_read_b64_tr_b16 v[110:111], v6 offset:3840
  s_waitcnt lgkmcnt(5)
  v_mfma_f32_32x32x16_bf16 v[32:47], v[80:83], v[100:103], v[32:47]
  ds_read_b64_tr_b16 v[112:113], v6 offset:3136
  ds_read_b64_tr_b16 v[114:115], v6 offset:3904
  s_waitcnt lgkmcnt(5)
  v_mfma_f32_32x32x16_bf16 v[48:63], v[80:83], v[104:107], v[48:63]
  ds_read_b64_tr_b16 v[116:117], v6 offset:3200
  ds_read_b64_tr_b16 v[118:119], v6 offset:3968
  s_waitcnt lgkmcnt(4)
  v_mfma_f32_32x32x16_bf16 v[16:31], v[84:87], v[108:111], v[16:31]
  ds_read_b128 v[88:91], v4
  ds_read_b64_tr_b16 v[96:97], v6 offset:6144
  ds_read_b64_tr_b16 v[98:99], v6 offset:6912
  s_waitcnt lgkmcnt(5)
  v_mfma_f32_32x32x16_bf16 v[32:47], v[84:87], v[112:115], v[32:47]
  ds_read_b64_tr_b16 v[100:101], v6 offset:6208
  ds_read_b64_tr_b16 v[102:103], v6 offset:6976
  s_waitcnt lgkmcnt(5)
  v_mfma_f32_32x32x16_bf16 v[48:63], v[84:87], v[116:119], v[48:63]
  ds_read_b64_tr_b16 v[104:105], v6 offset:6272
  ds_read_b64_tr_b16 v[106:107], v6 offset:7040
  s_waitcnt lgkmcnt(4)
  v_mfma_f32_32x32x16_bf16 v[16:31], v[88:91], v[96:99], v[16:31]
  ds_read_b128 v[92:95], v5
  ds_read_b64_tr_b16 v[108:109], v6 offset:9216
  ds_read_b64_tr_b16 v[110:111], v6 offset:9984
  s_waitcnt lgkmcnt(5)
  v_mfma_f32_32x32x16_bf16 v[32:47], v[88:91], v[100:103], v[32:47]
  ds_read_b64_tr_b16 v[112:113], v6 offset:9280
  ds_read_b64_tr_b16 v[114:115], v6 offset:10048
  s_waitcnt lgkmcnt(5)
  v_mfma_f32_32x32x16_bf16 v[48:63], v[88:91], v[104:107], v[48:63]
  ds_read_b64_tr_b16 v[116:117], v6 offset:9344
  ds_read_b64_tr_b16 v[118:119], v6 offset:10112
  s_waitcnt lgkmcnt(4)
  v_mfma_f32_32x32x16_bf16 v[16:31], v[92:95], v[108:111], v[16:31]
  s_waitcnt lgkmcnt(2)
  v_mfma_f32_32x32x16_bf16 v[32:47], v[92:95], v[112:115], v[32:47]
  s_waitcnt lgkmcnt(0)
  v_mfma_f32_32x32x16_bf16 v[48:63], v[92:95], v[116:119], v[48:63]
sequential_preLN__mha_block__dense_activation_squared_relu__prompt_kernel_ave_6:
  s_barrier
  v_dot2_f32_bf16 v120, v80, v128, v120
  v_dot2_f32_bf16 v124, v80, v80, v124
  v_dot2_f32_bf16 v121, v81, v128, v121
  v_dot2_f32_bf16 v125, v81, v81, v125
  v_dot2_f32_bf16 v122, v82, v128, v122
  v_dot2_f32_bf16 v126, v82, v82, v126
  v_dot2_f32_bf16 v123, v83, v128, v123
  v_dot2_f32_bf16 v127, v83, v83, v127
  v_dot2_f32_bf16 v120, v84, v128, v120
  v_dot2_f32_bf16 v124, v84, v84, v124
  v_dot2_f32_bf16 v121, v85, v128, v121
  v_dot2_f32_bf16 v125, v85, v85, v125
  v_dot2_f32_bf16 v122, v86, v128, v122
  v_dot2_f32_bf16 v126, v86, v86, v126
  v_dot2_f32_bf16 v123, v87, v128, v123
  v_dot2_f32_bf16 v127, v87, v87, v127
  v_dot2_f32_bf16 v120, v88, v128, v120
  v_dot2_f32_bf16 v124, v88, v88, v124
  v_dot2_f32_bf16 v121, v89, v128, v121
  v_dot2_f32_bf16 v125, v89, v89, v125
  v_dot2_f32_bf16 v122, v90, v128, v122
  v_dot2_f32_bf16 v126, v90, v90, v126
  v_dot2_f32_bf16 v123, v91, v128, v123
  v_dot2_f32_bf16 v127, v91, v91, v127
  v_dot2_f32_bf16 v120, v92, v128, v120
  v_dot2_f32_bf16 v124, v92, v92, v124
  v_dot2_f32_bf16 v121, v93, v128, v121
  v_dot2_f32_bf16 v125, v93, v93, v125
  v_dot2_f32_bf16 v122, v94, v128, v122
  v_dot2_f32_bf16 v126, v94, v94, v126
  v_dot2_f32_bf16 v123, v95, v128, v123
  v_dot2_f32_bf16 v127, v95, v95, v127
  s_nop 2
  v_add_f32 v120, v120, v121
  v_add_f32 v122, v122, v123
  v_add_f32 v124, v124, v125
  v_add_f32 v126, v126, v127
  v_add_f32 v120, v120, v122
  v_add_f32 v122, v124, v126
  v_mov_b32 v121, v120
  v_mov_b32 v123, v122
  s_nop 1
  v_permlane32_swap_b32 v120, v121
  v_permlane32_swap_b32 v122, v123
  s_nop 1
  v_add_f32 v120, v120, v121
  v_add_f32 v122, v122, v123
  s_mov_b32 s51, 0x3b000000
  v_mul_f32 v120, s51, v120
  v_mul_f32 v122, s51, v122
  v_fma_f32 v122, -v120, v120, v122
  v_max_f32 v122, 0, v122
  v_add_f32 v122, 0x3727c5ac, v122
  v_rsq_f32 v122, v122
  s_nop 0
  v_mul_f32 v124, 0x3eb8aa3b, v122
  s_cmp_lt_u32 s47, 10
  s_cbranch_scc1 sequential_preLN__mha_block__dense_activation_squared_relu__prompt_kernel_nov_16
  v_add_u32 v12, s50, v8
  v_lshlrev_b32 v12, 2, v12
  v_add_u32 v12, 143872, v12
  ds_write_b32 v12, v120
  ds_write_b32 v12, v122 offset:512
  v_lshlrev_b32 v13, 4, v9
  s_lshl_b32 s51, s50, 2
  s_add_u32 s51, s51, 143872
  v_add_u32 v14, s51, v13
  ds_read_b128 v[64:67], v14 offset:0
  ds_read_b128 v[80:83], v14 offset:512
  ds_read_b128 v[68:71], v14 offset:32
  ds_read_b128 v[84:87], v14 offset:544
  ds_read_b128 v[72:75], v14 offset:64
  ds_read_b128 v[88:91], v14 offset:576
  ds_read_b128 v[76:79], v14 offset:96
  ds_read_b128 v[92:95], v14 offset:608
sequential_preLN__mha_block__dense_activation_squared_relu__prompt_kernel_nov_16:
  s_barrier
  v_lshlrev_b32 v13, 4, v9
  v_add_u32 v13, 143360, v13
  v_lshlrev_b32 v14, 2, v8
  v_add_u32 v14, 143360, v14
  ds_read_b128 v[184:187], v13 offset:0
  ds_read_b128 v[188:191], v13 offset:32
  ds_read_b128 v[192:195], v13 offset:64
  ds_read_b128 v[196:199], v13 offset:96
  ds_read_b32 v232, v14 offset:0
  ds_read_b128 v[200:203], v13 offset:128
  ds_read_b128 v[204:207], v13 offset:160
  ds_read_b128 v[208:211], v13 offset:192
  ds_read_b128 v[212:215], v13 offset:224
  ds_read_b32 v234, v14 offset:128
  ds_read_b128 v[216:219], v13 offset:256
  ds_read_b128 v[220:223], v13 offset:288
  ds_read_b128 v[224:227], v13 offset:320
  ds_read_b128 v[228:231], v13 offset:352
  ds_read_b32 v236, v14 offset:256
  v_lshlrev_b32 v15, 4, v0
  v_bfe_u32 v12, v0, 4, 1
  v_lshlrev_b32 v12, 16, v12
  v_lshl_add_u32 v12, v9, 8, v12
  v_and_b32 v13, 15, v0
  v_lshl_add_u32 v12, v13, 4, v12
  s_lshl_b32 s52, s46, 2
  s_add_u32 s52, s52, s3
  s_mul_i32 s53, s47, 3
  s_add_u32 s54, s53, 0
  s_waitcnt lgkmcnt(0)
  s_cmp_ge_u32 s54, 32
  s_cbranch_scc1 sequential_preLN__mha_block__dense_activation_squared_relu__prompt_kernel_ev_17
  v_pk_fma_f32 v[16:17], v[184:185], v[120:121], v[16:17] op_sel_hi:[1,0,1] neg_lo:[0,1,0] neg_hi:[0,1,0]
  v_pk_fma_f32 v[18:19], v[186:187], v[120:121], v[18:19] op_sel_hi:[1,0,1] neg_lo:[0,1,0] neg_hi:[0,1,0]
  v_pk_fma_f32 v[20:21], v[188:189], v[120:121], v[20:21] op_sel_hi:[1,0,1] neg_lo:[0,1,0] neg_hi:[0,1,0]
  v_pk_fma_f32 v[22:23], v[190:191], v[120:121], v[22:23] op_sel_hi:[1,0,1] neg_lo:[0,1,0] neg_hi:[0,1,0]
  v_pk_fma_f32 v[24:25], v[192:193], v[120:121], v[24:25] op_sel_hi:[1,0,1] neg_lo:[0,1,0] neg_hi:[0,1,0]
  v_pk_fma_f32 v[26:27], v[194:195], v[120:121], v[26:27] op_sel_hi:[1,0,1] neg_lo:[0,1,0] neg_hi:[0,1,0]
  v_pk_fma_f32 v[28:29], v[196:197], v[120:121], v[28:29] op_sel_hi:[1,0,1] neg_lo:[0,1,0] neg_hi:[0,1,0]
  v_pk_fma_f32 v[30:31], v[198:199], v[120:121], v[30:31] op_sel_hi:[1,0,1] neg_lo:[0,1,0] neg_hi:[0,1,0]
  s_cmp_lt_u32 s54, 16
  s_cbranch_scc1 sequential_preLN__mha_block__dense_activation_squared_relu__prompt_kernel_eq_19
  v_pk_mul_f32 v[16:17], v[16:17], v[122:123] op_sel_hi:[1,0]
  v_pk_mul_f32 v[18:19], v[18:19], v[122:123] op_sel_hi:[1,0]
  v_pk_mul_f32 v[20:21], v[20:21], v[122:123] op_sel_hi:[1,0]
  v_pk_mul_f32 v[22:23], v[22:23], v[122:123] op_sel_hi:[1,0]
  v_pk_mul_f32 v[24:25], v[24:25], v[122:123] op_sel_hi:[1,0]
  v_pk_mul_f32 v[26:27], v[26:27], v[122:123] op_sel_hi:[1,0]
  v_pk_mul_f32 v[28:29], v[28:29], v[122:123] op_sel_hi:[1,0]
  v_pk_mul_f32 v[30:31], v[30:31], v[122:123] op_sel_hi:[1,0]
  s_mov_b32 s55, 2097152
  s_branch sequential_preLN__mha_block__dense_activation_squared_relu__prompt_kernel_eq2_20
sequential_preLN__mha_block__dense_activation_squared_relu__prompt_kernel_eq_19:
  v_pk_mul_f32 v[16:17], v[16:17], v[124:125] op_sel_hi:[1,0]
  v_pk_mul_f32 v[18:19], v[18:19], v[124:125] op_sel_hi:[1,0]
  v_pk_mul_f32 v[20:21], v[20:21], v[124:125] op_sel_hi:[1,0]
  v_pk_mul_f32 v[22:23], v[22:23], v[124:125] op_sel_hi:[1,0]
  v_pk_mul_f32 v[24:25], v[24:25], v[124:125] op_sel_hi:[1,0]
  v_pk_mul_f32 v[26:27], v[26:27], v[124:125] op_sel_hi:[1,0]
  v_pk_mul_f32 v[28:29], v[28:29], v[124:125] op_sel_hi:[1,0]
  v_pk_mul_f32 v[30:31], v[30:31], v[124:125] op_sel_hi:[1,0]
  s_mov_b32 s55, 0
sequential_preLN__mha_block__dense_activation_squared_relu__prompt_kernel_eq2_20:
  v_cvt_pk_bf16_f32 v160, v16, v17
  v_cvt_pk_bf16_f32 v161, v18, v19
  v_cvt_pk_bf16_f32 v162, v20, v21
  v_cvt_pk_bf16_f32 v163, v22, v23
  v_cvt_pk_bf16_f32 v164, v24, v25
  v_cvt_pk_bf16_f32 v165, v26, v27
  v_cvt_pk_bf16_f32 v166, v28, v29
  v_cvt_pk_bf16_f32 v167, v30, v31
  s_and_b32 s56, s54, 15
  s_lshl_b32 s56, s56, 7
  s_add_u32 s56, s56, s52
  s_lshl_b32 s56, s56, 10
  s_add_u32 s56, s56, s55
  s_add_u32 s57, s56, 65536
  buffer_store_dwordx4 v[160:163], v15, s[8:11], s56 offen sc1
  buffer_store_dwordx4 v[164:167], v15, s[8:11], s57 offen sc1
  s_branch sequential_preLN__mha_block__dense_activation_squared_relu__prompt_kernel_en_18
sequential_preLN__mha_block__dense_activation_squared_relu__prompt_kernel_ev_17:
  v_pk_fma_f32 v[16:17], v[64:65], v[232:233], v[16:17] op_sel_hi:[1,0,1] neg_lo:[0,1,0] neg_hi:[0,1,0]
  v_pk_fma_f32 v[18:19], v[66:67], v[232:233], v[18:19] op_sel_hi:[1,0,1] neg_lo:[0,1,0] neg_hi:[0,1,0]
  v_pk_fma_f32 v[20:21], v[68:69], v[232:233], v[20:21] op_sel_hi:[1,0,1] neg_lo:[0,1,0] neg_hi:[0,1,0]
  v_pk_fma_f32 v[22:23], v[70:71], v[232:233], v[22:23] op_sel_hi:[1,0,1] neg_lo:[0,1,0] neg_hi:[0,1,0]
  v_pk_fma_f32 v[24:25], v[72:73], v[232:233], v[24:25] op_sel_hi:[1,0,1] neg_lo:[0,1,0] neg_hi:[0,1,0]
  v_pk_fma_f32 v[26:27], v[74:75], v[232:233], v[26:27] op_sel_hi:[1,0,1] neg_lo:[0,1,0] neg_hi:[0,1,0]
  v_pk_fma_f32 v[28:29], v[76:77], v[232:233], v[28:29] op_sel_hi:[1,0,1] neg_lo:[0,1,0] neg_hi:[0,1,0]
  v_pk_fma_f32 v[30:31], v[78:79], v[232:233], v[30:31] op_sel_hi:[1,0,1] neg_lo:[0,1,0] neg_hi:[0,1,0]
  v_pk_mul_f32 v[16:17], v[16:17], v[80:81]
  v_pk_mul_f32 v[18:19], v[18:19], v[82:83]
  v_pk_mul_f32 v[20:21], v[20:21], v[84:85]
  v_pk_mul_f32 v[22:23], v[22:23], v[86:87]
  v_pk_mul_f32 v[24:25], v[24:25], v[88:89]
  v_pk_mul_f32 v[26:27], v[26:27], v[90:91]
  v_pk_mul_f32 v[28:29], v[28:29], v[92:93]
  v_pk_mul_f32 v[30:31], v[30:31], v[94:95]
  v_cvt_pk_bf16_f32 v160, v16, v17
  v_cvt_pk_bf16_f32 v161, v18, v19
  v_cvt_pk_bf16_f32 v162, v20, v21
  v_cvt_pk_bf16_f32 v163, v22, v23
  v_cvt_pk_bf16_f32 v164, v24, v25
  v_cvt_pk_bf16_f32 v165, v26, v27
  v_cvt_pk_bf16_f32 v166, v28, v29
  v_cvt_pk_bf16_f32 v167, v30, v31
  s_sub_u32 s56, s54, 32
  s_lshl_b32 s56, s56, 8
  s_lshl_b32 s57, s52, 1
  s_add_u32 s56, s56, s57
  s_lshl_b32 s56, s56, 9
  s_add_u32 s56, s56, 4194304
  buffer_store_dwordx4 v[160:163], v12, s[8:11], s56 offen sc1
  buffer_store_dwordx4 v[164:167], v12, s[8:11], s56 offen offset:512 sc1
sequential_preLN__mha_block__dense_activation_squared_relu__prompt_kernel_en_18:
  s_add_u32 s54, s53, 1
  s_cmp_ge_u32 s54, 32
  s_cbranch_scc1 sequential_preLN__mha_block__dense_activation_squared_relu__prompt_kernel_ev_21
  v_pk_fma_f32 v[32:33], v[200:201], v[120:121], v[32:33] op_sel_hi:[1,0,1] neg_lo:[0,1,0] neg_hi:[0,1,0]
  v_pk_fma_f32 v[34:35], v[202:203], v[120:121], v[34:35] op_sel_hi:[1,0,1] neg_lo:[0,1,0] neg_hi:[0,1,0]
  v_pk_fma_f32 v[36:37], v[204:205], v[120:121], v[36:37] op_sel_hi:[1,0,1] neg_lo:[0,1,0] neg_hi:[0,1,0]
  v_pk_fma_f32 v[38:39], v[206:207], v[120:121], v[38:39] op_sel_hi:[1,0,1] neg_lo:[0,1,0] neg_hi:[0,1,0]
  v_pk_fma_f32 v[40:41], v[208:209], v[120:121], v[40:41] op_sel_hi:[1,0,1] neg_lo:[0,1,0] neg_hi:[0,1,0]
  v_pk_fma_f32 v[42:43], v[210:211], v[120:121], v[42:43] op_sel_hi:[1,0,1] neg_lo:[0,1,0] neg_hi:[0,1,0]
  v_pk_fma_f32 v[44:45], v[212:213], v[120:121], v[44:45] op_sel_hi:[1,0,1] neg_lo:[0,1,0] neg_hi:[0,1,0]
  v_pk_fma_f32 v[46:47], v[214:215], v[120:121], v[46:47] op_sel_hi:[1,0,1] neg_lo:[0,1,0] neg_hi:[0,1,0]
  s_cmp_lt_u32 s54, 16
  s_cbranch_scc1 sequential_preLN__mha_block__dense_activation_squared_relu__prompt_kernel_eq_23
  v_pk_mul_f32 v[32:33], v[32:33], v[122:123] op_sel_hi:[1,0]
  v_pk_mul_f32 v[34:35], v[34:35], v[122:123] op_sel_hi:[1,0]
  v_pk_mul_f32 v[36:37], v[36:37], v[122:123] op_sel_hi:[1,0]
  v_pk_mul_f32 v[38:39], v[38:39], v[122:123] op_sel_hi:[1,0]
  v_pk_mul_f32 v[40:41], v[40:41], v[122:123] op_sel_hi:[1,0]
  v_pk_mul_f32 v[42:43], v[42:43], v[122:123] op_sel_hi:[1,0]
  v_pk_mul_f32 v[44:45], v[44:45], v[122:123] op_sel_hi:[1,0]
  v_pk_mul_f32 v[46:47], v[46:47], v[122:123] op_sel_hi:[1,0]
  s_mov_b32 s55, 2097152
  s_branch sequential_preLN__mha_block__dense_activation_squared_relu__prompt_kernel_eq2_24
sequential_preLN__mha_block__dense_activation_squared_relu__prompt_kernel_eq_23:
  v_pk_mul_f32 v[32:33], v[32:33], v[124:125] op_sel_hi:[1,0]
  v_pk_mul_f32 v[34:35], v[34:35], v[124:125] op_sel_hi:[1,0]
  v_pk_mul_f32 v[36:37], v[36:37], v[124:125] op_sel_hi:[1,0]
  v_pk_mul_f32 v[38:39], v[38:39], v[124:125] op_sel_hi:[1,0]
  v_pk_mul_f32 v[40:41], v[40:41], v[124:125] op_sel_hi:[1,0]
  v_pk_mul_f32 v[42:43], v[42:43], v[124:125] op_sel_hi:[1,0]
  v_pk_mul_f32 v[44:45], v[44:45], v[124:125] op_sel_hi:[1,0]
  v_pk_mul_f32 v[46:47], v[46:47], v[124:125] op_sel_hi:[1,0]
  s_mov_b32 s55, 0
sequential_preLN__mha_block__dense_activation_squared_relu__prompt_kernel_eq2_24:
  v_cvt_pk_bf16_f32 v168, v32, v33
  v_cvt_pk_bf16_f32 v169, v34, v35
  v_cvt_pk_bf16_f32 v170, v36, v37
  v_cvt_pk_bf16_f32 v171, v38, v39
  v_cvt_pk_bf16_f32 v172, v40, v41
  v_cvt_pk_bf16_f32 v173, v42, v43
  v_cvt_pk_bf16_f32 v174, v44, v45
  v_cvt_pk_bf16_f32 v175, v46, v47
  s_and_b32 s56, s54, 15
  s_lshl_b32 s56, s56, 7
  s_add_u32 s56, s56, s52
  s_lshl_b32 s56, s56, 10
  s_add_u32 s56, s56, s55
  s_add_u32 s57, s56, 65536
  buffer_store_dwordx4 v[168:171], v15, s[8:11], s56 offen sc1
  buffer_store_dwordx4 v[172:175], v15, s[8:11], s57 offen sc1
  s_branch sequential_preLN__mha_block__dense_activation_squared_relu__prompt_kernel_en_22
sequential_preLN__mha_block__dense_activation_squared_relu__prompt_kernel_ev_21:
  v_pk_fma_f32 v[32:33], v[64:65], v[234:235], v[32:33] op_sel_hi:[1,0,1] neg_lo:[0,1,0] neg_hi:[0,1,0]
  v_pk_fma_f32 v[34:35], v[66:67], v[234:235], v[34:35] op_sel_hi:[1,0,1] neg_lo:[0,1,0] neg_hi:[0,1,0]
  v_pk_fma_f32 v[36:37], v[68:69], v[234:235], v[36:37] op_sel_hi:[1,0,1] neg_lo:[0,1,0] neg_hi:[0,1,0]
  v_pk_fma_f32 v[38:39], v[70:71], v[234:235], v[38:39] op_sel_hi:[1,0,1] neg_lo:[0,1,0] neg_hi:[0,1,0]
  v_pk_fma_f32 v[40:41], v[72:73], v[234:235], v[40:41] op_sel_hi:[1,0,1] neg_lo:[0,1,0] neg_hi:[0,1,0]
  v_pk_fma_f32 v[42:43], v[74:75], v[234:235], v[42:43] op_sel_hi:[1,0,1] neg_lo:[0,1,0] neg_hi:[0,1,0]
  v_pk_fma_f32 v[44:45], v[76:77], v[234:235], v[44:45] op_sel_hi:[1,0,1] neg_lo:[0,1,0] neg_hi:[0,1,0]
  v_pk_fma_f32 v[46:47], v[78:79], v[234:235], v[46:47] op_sel_hi:[1,0,1] neg_lo:[0,1,0] neg_hi:[0,1,0]
  v_pk_mul_f32 v[32:33], v[32:33], v[80:81]
  v_pk_mul_f32 v[34:35], v[34:35], v[82:83]
  v_pk_mul_f32 v[36:37], v[36:37], v[84:85]
  v_pk_mul_f32 v[38:39], v[38:39], v[86:87]
  v_pk_mul_f32 v[40:41], v[40:41], v[88:89]
  v_pk_mul_f32 v[42:43], v[42:43], v[90:91]
  v_pk_mul_f32 v[44:45], v[44:45], v[92:93]
  v_pk_mul_f32 v[46:47], v[46:47], v[94:95]
  v_cvt_pk_bf16_f32 v168, v32, v33
  v_cvt_pk_bf16_f32 v169, v34, v35
  v_cvt_pk_bf16_f32 v170, v36, v37
  v_cvt_pk_bf16_f32 v171, v38, v39
  v_cvt_pk_bf16_f32 v172, v40, v41
  v_cvt_pk_bf16_f32 v173, v42, v43
  v_cvt_pk_bf16_f32 v174, v44, v45
  v_cvt_pk_bf16_f32 v175, v46, v47
  s_sub_u32 s56, s54, 32
  s_lshl_b32 s56, s56, 8
  s_lshl_b32 s57, s52, 1
  s_add_u32 s56, s56, s57
  s_lshl_b32 s56, s56, 9
  s_add_u32 s56, s56, 4194304
  buffer_store_dwordx4 v[168:171], v12, s[8:11], s56 offen sc1
  buffer_store_dwordx4 v[172:175], v12, s[8:11], s56 offen offset:512 sc1
sequential_preLN__mha_block__dense_activation_squared_relu__prompt_kernel_en_22:
  s_add_u32 s54, s53, 2
  s_cmp_ge_u32 s54, 32
  s_cbranch_scc1 sequential_preLN__mha_block__dense_activation_squared_relu__prompt_kernel_ev_25
  v_pk_fma_f32 v[48:49], v[216:217], v[120:121], v[48:49] op_sel_hi:[1,0,1] neg_lo:[0,1,0] neg_hi:[0,1,0]
  v_pk_fma_f32 v[50:51], v[218:219], v[120:121], v[50:51] op_sel_hi:[1,0,1] neg_lo:[0,1,0] neg_hi:[0,1,0]
  v_pk_fma_f32 v[52:53], v[220:221], v[120:121], v[52:53] op_sel_hi:[1,0,1] neg_lo:[0,1,0] neg_hi:[0,1,0]
  v_pk_fma_f32 v[54:55], v[222:223], v[120:121], v[54:55] op_sel_hi:[1,0,1] neg_lo:[0,1,0] neg_hi:[0,1,0]
  v_pk_fma_f32 v[56:57], v[224:225], v[120:121], v[56:57] op_sel_hi:[1,0,1] neg_lo:[0,1,0] neg_hi:[0,1,0]
  v_pk_fma_f32 v[58:59], v[226:227], v[120:121], v[58:59] op_sel_hi:[1,0,1] neg_lo:[0,1,0] neg_hi:[0,1,0]
  v_pk_fma_f32 v[60:61], v[228:229], v[120:121], v[60:61] op_sel_hi:[1,0,1] neg_lo:[0,1,0] neg_hi:[0,1,0]
  v_pk_fma_f32 v[62:63], v[230:231], v[120:121], v[62:63] op_sel_hi:[1,0,1] neg_lo:[0,1,0] neg_hi:[0,1,0]
  s_cmp_lt_u32 s54, 16
  s_cbranch_scc1 sequential_preLN__mha_block__dense_activation_squared_relu__prompt_kernel_eq_27
  v_pk_mul_f32 v[48:49], v[48:49], v[122:123] op_sel_hi:[1,0]
  v_pk_mul_f32 v[50:51], v[50:51], v[122:123] op_sel_hi:[1,0]
  v_pk_mul_f32 v[52:53], v[52:53], v[122:123] op_sel_hi:[1,0]
  v_pk_mul_f32 v[54:55], v[54:55], v[122:123] op_sel_hi:[1,0]
  v_pk_mul_f32 v[56:57], v[56:57], v[122:123] op_sel_hi:[1,0]
  v_pk_mul_f32 v[58:59], v[58:59], v[122:123] op_sel_hi:[1,0]
  v_pk_mul_f32 v[60:61], v[60:61], v[122:123] op_sel_hi:[1,0]
  v_pk_mul_f32 v[62:63], v[62:63], v[122:123] op_sel_hi:[1,0]
  s_mov_b32 s55, 2097152
  s_branch sequential_preLN__mha_block__dense_activation_squared_relu__prompt_kernel_eq2_28
sequential_preLN__mha_block__dense_activation_squared_relu__prompt_kernel_eq_27:
  v_pk_mul_f32 v[48:49], v[48:49], v[124:125] op_sel_hi:[1,0]
  v_pk_mul_f32 v[50:51], v[50:51], v[124:125] op_sel_hi:[1,0]
  v_pk_mul_f32 v[52:53], v[52:53], v[124:125] op_sel_hi:[1,0]
  v_pk_mul_f32 v[54:55], v[54:55], v[124:125] op_sel_hi:[1,0]
  v_pk_mul_f32 v[56:57], v[56:57], v[124:125] op_sel_hi:[1,0]
  v_pk_mul_f32 v[58:59], v[58:59], v[124:125] op_sel_hi:[1,0]
  v_pk_mul_f32 v[60:61], v[60:61], v[124:125] op_sel_hi:[1,0]
  v_pk_mul_f32 v[62:63], v[62:63], v[124:125] op_sel_hi:[1,0]
  s_mov_b32 s55, 0
sequential_preLN__mha_block__dense_activation_squared_relu__prompt_kernel_eq2_28:
  v_cvt_pk_bf16_f32 v176, v48, v49
  v_cvt_pk_bf16_f32 v177, v50, v51
  v_cvt_pk_bf16_f32 v178, v52, v53
  v_cvt_pk_bf16_f32 v179, v54, v55
  v_cvt_pk_bf16_f32 v180, v56, v57
  v_cvt_pk_bf16_f32 v181, v58, v59
  v_cvt_pk_bf16_f32 v182, v60, v61
  v_cvt_pk_bf16_f32 v183, v62, v63
  s_and_b32 s56, s54, 15
  s_lshl_b32 s56, s56, 7
  s_add_u32 s56, s56, s52
  s_lshl_b32 s56, s56, 10
  s_add_u32 s56, s56, s55
  s_add_u32 s57, s56, 65536
  buffer_store_dwordx4 v[176:179], v15, s[8:11], s56 offen sc1
  buffer_store_dwordx4 v[180:183], v15, s[8:11], s57 offen sc1
  s_branch sequential_preLN__mha_block__dense_activation_squared_relu__prompt_kernel_en_26
sequential_preLN__mha_block__dense_activation_squared_relu__prompt_kernel_ev_25:
  v_pk_fma_f32 v[48:49], v[64:65], v[236:237], v[48:49] op_sel_hi:[1,0,1] neg_lo:[0,1,0] neg_hi:[0,1,0]
  v_pk_fma_f32 v[50:51], v[66:67], v[236:237], v[50:51] op_sel_hi:[1,0,1] neg_lo:[0,1,0] neg_hi:[0,1,0]
  v_pk_fma_f32 v[52:53], v[68:69], v[236:237], v[52:53] op_sel_hi:[1,0,1] neg_lo:[0,1,0] neg_hi:[0,1,0]
  v_pk_fma_f32 v[54:55], v[70:71], v[236:237], v[54:55] op_sel_hi:[1,0,1] neg_lo:[0,1,0] neg_hi:[0,1,0]
  v_pk_fma_f32 v[56:57], v[72:73], v[236:237], v[56:57] op_sel_hi:[1,0,1] neg_lo:[0,1,0] neg_hi:[0,1,0]
  v_pk_fma_f32 v[58:59], v[74:75], v[236:237], v[58:59] op_sel_hi:[1,0,1] neg_lo:[0,1,0] neg_hi:[0,1,0]
  v_pk_fma_f32 v[60:61], v[76:77], v[236:237], v[60:61] op_sel_hi:[1,0,1] neg_lo:[0,1,0] neg_hi:[0,1,0]
  v_pk_fma_f32 v[62:63], v[78:79], v[236:237], v[62:63] op_sel_hi:[1,0,1] neg_lo:[0,1,0] neg_hi:[0,1,0]
  v_pk_mul_f32 v[48:49], v[48:49], v[80:81]
  v_pk_mul_f32 v[50:51], v[50:51], v[82:83]
  v_pk_mul_f32 v[52:53], v[52:53], v[84:85]
  v_pk_mul_f32 v[54:55], v[54:55], v[86:87]
  v_pk_mul_f32 v[56:57], v[56:57], v[88:89]
  v_pk_mul_f32 v[58:59], v[58:59], v[90:91]
  v_pk_mul_f32 v[60:61], v[60:61], v[92:93]
  v_pk_mul_f32 v[62:63], v[62:63], v[94:95]
  v_cvt_pk_bf16_f32 v176, v48, v49
  v_cvt_pk_bf16_f32 v177, v50, v51
  v_cvt_pk_bf16_f32 v178, v52, v53
  v_cvt_pk_bf16_f32 v179, v54, v55
  v_cvt_pk_bf16_f32 v180, v56, v57
  v_cvt_pk_bf16_f32 v181, v58, v59
  v_cvt_pk_bf16_f32 v182, v60, v61
  v_cvt_pk_bf16_f32 v183, v62, v63
  s_sub_u32 s56, s54, 32
  s_lshl_b32 s56, s56, 8
  s_lshl_b32 s57, s52, 1
  s_add_u32 s56, s56, s57
  s_lshl_b32 s56, s56, 9
  s_add_u32 s56, s56, 4194304
  buffer_store_dwordx4 v[176:179], v12, s[8:11], s56 offen sc1
  buffer_store_dwordx4 v[180:183], v12, s[8:11], s56 offen offset:512 sc1
sequential_preLN__mha_block__dense_activation_squared_relu__prompt_kernel_en_26:
  s_cmp_lg_u32 s3, 0
  s_cbranch_scc1 sequential_preLN__mha_block__dense_activation_squared_relu__prompt_kernel_nw0_29
  s_mov_b32 s58, 0
  v_mov_b32 v149, 0
  s_waitcnt vmcnt(6)
  s_branch sequential_preLN__mha_block__dense_activation_squared_relu__prompt_kernel_nf0_32
sequential_preLN__mha_block__dense_activation_squared_relu__prompt_kernel_ng_30:
  s_waitcnt vmcnt(0)
sequential_preLN__mha_block__dense_activation_squared_relu__prompt_kernel_nf0_32:
  v_readfirstlane_b32 s4, v148
  s_add_u32 s58, s58, 1
  s_cmp_gt_u32 s58, 200000
  s_cbranch_scc1 sequential_preLN__mha_block__dense_activation_squared_relu__prompt_kernel_nd_31
  s_cmp_lg_u32 s4, 0
  s_cbranch_scc1 sequential_preLN__mha_block__dense_activation_squared_relu__prompt_kernel_nd_31
  buffer_load_dword v148, v149, s[20:23], 0 offen sc1
  s_branch sequential_preLN__mha_block__dense_activation_squared_relu__prompt_kernel_ng_30
sequential_preLN__mha_block__dense_activation_squared_relu__prompt_kernel_nd_31:
  v_mov_b32 v2, 149504
  v_mov_b32 v3, s4
  v_mov_b32 v4, 0
  ds_write_b32 v2, v3
  ds_write_b32 v2, v4 offset:4
  ds_write_b32 v2, v4 offset:8
  s_waitcnt lgkmcnt(0)
sequential_preLN__mha_block__dense_activation_squared_relu__prompt_kernel_nw0_29:
  s_waitcnt vmcnt(0)
  s_branch sequential_preLN__mha_block__dense_activation_squared_relu__prompt_kernel_A_join
sequential_preLN__mha_block__dense_activation_squared_relu__prompt_kernel_A_helper:
  s_sub_u32 s48, s3, 4
  v_lshrrev_b32 v2, 3, v0
  s_lshl_b32 s50, s46, 7
  s_lshl_b32 s51, s48, 3
  s_add_u32 s50, s50, s51
  v_add_u32 v2, s50, v2
  v_lshlrev_b32 v2, 10, v2
  v_lshrrev_b32 v3, 4, v0
  s_and_b32 s51, s48, 1
  s_lshl_b32 s51, s51, 2
  v_add_u32 v3, s51, v3
  v_and_b32 v4, 7, v0
  v_xor_b32 v3, v3, v4
  v_lshl_add_u32 v2, v3, 4, v2
  s_lshl_b32 s54, s48, 10
  s_add_u32 m0, s54, 0
  s_mov_b32 s55, 0
  buffer_load_dwordx4 v2, s[12:15], s55 offen lds
  s_add_u32 m0, s54, 4096
  s_mov_b32 s55, 32768
  buffer_load_dwordx4 v2, s[12:15], s55 offen lds
  s_add_u32 m0, s54, 8192
  s_mov_b32 s55, 65536
  buffer_load_dwordx4 v2, s[12:15], s55 offen lds
  s_add_u32 m0, s54, 12288
  s_mov_b32 s55, 98304
  buffer_load_dwordx4 v2, s[12:15], s55 offen lds
  s_lshl_b32 s51, s48, 6
  s_mul_i32 s52, s47, 192
  s_mov_b32 s53, 43691
  v_add_u32 v6, s51, v0
  v_mul_lo_u32 v7, v6, s53
  v_lshrrev_b32 v7, 19, v7
  v_mul_u32_u24 v8, 12, v7
  v_sub_u32 v8, v6, v8
  v_mul_u32_u24 v7, 3072, v7
  v_lshl_add_u32 v7, v8, 4, v7
  v_add_u32 v3, s52, v7
  v_add_u32 v6, s51, v0
  v_add_u32 v6, 256, v6
  v_mul_lo_u32 v7, v6, s53
  v_lshrrev_b32 v7, 19, v7
  v_mul_u32_u24 v8, 12, v7
  v_sub_u32 v8, v6, v8
  v_mul_u32_u24 v7, 3072, v7
  v_lshl_add_u32 v7, v8, 4, v7
  v_add_u32 v4, s52, v7
  v_add_u32 v6, s51, v0
  v_add_u32 v6, 512, v6
  v_mul_lo_u32 v7, v6, s53
  v_lshrrev_b32 v7, 19, v7
  v_mul_u32_u24 v8, 12, v7
  v_sub_u32 v8, v6, v8
  v_mul_u32_u24 v7, 3072, v7
  v_lshl_add_u32 v7, v8, 4, v7
  v_add_u32 v5, s52, v7
  s_add_u32 m0, s54, 16384
  s_mov_b32 s55, 0
  buffer_load_dwordx4 v3, s[16:19], s55 offen lds
  s_add_u32 m0, s54, 20480
  s_mov_b32 s55, 0
  buffer_load_dwordx4 v4, s[16:19], s55 offen lds
  s_add_u32 m0, s54, 24576
  s_mov_b32 s55, 0
  buffer_load_dwordx4 v5, s[16:19], s55 offen lds
  s_add_u32 m0, s54, 28672
  s_mov_b32 s55, 128
  buffer_load_dwordx4 v2, s[12:15], s55 offen lds
  s_add_u32 m0, s54, 32768
  s_mov_b32 s55, 32896
  buffer_load_dwordx4 v2, s[12:15], s55 offen lds
  s_add_u32 m0, s54, 36864
  s_mov_b32 s55, 65664
  buffer_load_dwordx4 v2, s[12:15], s55 offen lds
  s_add_u32 m0, s54, 40960
  s_mov_b32 s55, 98432
  buffer_load_dwordx4 v2, s[12:15], s55 offen lds
  s_add_u32 m0, s54, 45056
  s_mov_b32 s55, 196608
  buffer_load_dwordx4 v3, s[16:19], s55 offen lds
  s_add_u32 m0, s54, 49152
  s_mov_b32 s55, 196608
  buffer_load_dwordx4 v4, s[16:19], s55 offen lds
  s_add_u32 m0, s54, 53248
  s_mov_b32 s55, 196608
  buffer_load_dwordx4 v5, s[16:19], s55 offen lds
  s_add_u32 m0, s54, 57344
  s_mov_b32 s55, 256
  buffer_load_dwordx4 v2, s[12:15], s55 offen lds
  s_add_u32 m0, s54, 61440
  s_mov_b32 s55, 33024
  buffer_load_dwordx4 v2, s[12:15], s55 offen lds
  s_add_u32 m0, s54, 65536
  s_mov_b32 s55, 65792
  buffer_load_dwordx4 v2, s[12:15], s55 offen lds
  s_add_u32 m0, s54, 69632
  s_mov_b32 s55, 98560
  buffer_load_dwordx4 v2, s[12:15], s55 offen lds
  s_add_u32 m0, s54, 73728
  s_mov_b32 s55, 393216
  buffer_load_dwordx4 v3, s[16:19], s55 offen lds
  s_add_u32 m0, s54, 77824
  s_mov_b32 s55, 393216
  buffer_load_dwordx4 v4, s[16:19], s55 offen lds
  s_add_u32 m0, s54, 81920
  s_mov_b32 s55, 393216
  buffer_load_dwordx4 v5, s[16:19], s55 offen lds
  v_lshrrev_b32 v9, 5, v0
  v_bfe_u32 v12, v0, 2, 2
  v_lshl_add_u32 v12, v9, 3, v12
  v_mul_u32_u24 v12, 192, v12
  v_bfe_u32 v13, v0, 4, 1
  v_lshl_add_u32 v12, v13, 5, v12
  v_and_b32 v13, 3, v0
  v_lshl_add_u32 v12, v13, 3, v12
  s_mul_i32 s56, s48, 3072
  s_add_u32 s56, s56, 16384
  v_add_u32 v10, s56, v12
  v_mov_b32 v14, 0
  v_mov_b32 v15, 0
  v_mov_b32 v16, 0
  v_mov_b32 v17, 0
  v_mov_b32 v18, 0
  v_mov_b32 v19, 0
  v_mov_b32 v50, 0x3f803f80
  s_cmp_ge_u32 s48, 2
  s_cbranch_scc1 sequential_preLN__mha_block__dense_activation_squared_relu__prompt_kernel_hb_33
  s_waitcnt vmcnt(14)
  s_barrier
  ds_read_b64_tr_b16 v[20:21], v10 offset:0
  ds_read_b64_tr_b16 v[22:23], v10 offset:768
  ds_read_b64_tr_b16 v[24:25], v10 offset:64
  ds_read_b64_tr_b16 v[26:27], v10 offset:832
  ds_read_b64_tr_b16 v[28:29], v10 offset:128
  ds_read_b64_tr_b16 v[30:31], v10 offset:896
  s_mov_b32 s57, 28672
  v_add_u32 v10, s57, v10
  s_add_u32 m0, s54, 86016
  s_mov_b32 s55, 384
  buffer_load_dwordx4 v2, s[12:15], s55 offen lds
  s_add_u32 m0, s54, 90112
  s_mov_b32 s55, 33152
  buffer_load_dwordx4 v2, s[12:15], s55 offen lds
  s_add_u32 m0, s54, 94208
  s_mov_b32 s55, 65920
  buffer_load_dwordx4 v2, s[12:15], s55 offen lds
  s_add_u32 m0, s54, 98304
  s_mov_b32 s55, 98688
  buffer_load_dwordx4 v2, s[12:15], s55 offen lds
  s_add_u32 m0, s54, 102400
  s_mov_b32 s55, 589824
  buffer_load_dwordx4 v3, s[16:19], s55 offen lds
  s_add_u32 m0, s54, 106496
  s_mov_b32 s55, 589824
  buffer_load_dwordx4 v4, s[16:19], s55 offen lds
  s_add_u32 m0, s54, 110592
  s_mov_b32 s55, 589824
  buffer_load_dwordx4 v5, s[16:19], s55 offen lds
  s_waitcnt lgkmcnt(0)
  s_waitcnt vmcnt(14)
  s_barrier
  ds_read_b64_tr_b16 v[32:33], v10 offset:0
  ds_read_b64_tr_b16 v[34:35], v10 offset:768
  ds_read_b64_tr_b16 v[36:37], v10 offset:64
  ds_read_b64_tr_b16 v[38:39], v10 offset:832
  ds_read_b64_tr_b16 v[40:41], v10 offset:128
  ds_read_b64_tr_b16 v[42:43], v10 offset:896
  s_mov_b32 s57, 28672
  v_add_u32 v10, s57, v10
  s_add_u32 m0, s54, 114688
  s_mov_b32 s55, 512
  buffer_load_dwordx4 v2, s[12:15], s55 offen lds
  s_add_u32 m0, s54, 118784
  s_mov_b32 s55, 33280
  buffer_load_dwordx4 v2, s[12:15], s55 offen lds
  s_add_u32 m0, s54, 122880
  s_mov_b32 s55, 66048
  buffer_load_dwordx4 v2, s[12:15], s55 offen lds
  s_add_u32 m0, s54, 126976
  s_mov_b32 s55, 98816
  buffer_load_dwordx4 v2, s[12:15], s55 offen lds
  s_add_u32 m0, s54, 131072
  s_mov_b32 s55, 786432
  buffer_load_dwordx4 v3, s[16:19], s55 offen lds
  s_add_u32 m0, s54, 135168
  s_mov_b32 s55, 786432
  buffer_load_dwordx4 v4, s[16:19], s55 offen lds
  s_add_u32 m0, s54, 139264
  s_mov_b32 s55, 786432
  buffer_load_dwordx4 v5, s[16:19], s55 offen lds
  v_lshlrev_b32 v44, 16, v20
  v_and_b32 v45, 0xffff0000, v20
  v_add_f32 v14, v14, v44
  v_add_f32 v15, v15, v45
  v_lshlrev_b32 v46, 16, v21
  v_and_b32 v47, 0xffff0000, v21
  v_add_f32 v14, v14, v46
  v_add_f32 v15, v15, v47
  v_lshlrev_b32 v44, 16, v22
  v_and_b32 v45, 0xffff0000, v22
  v_add_f32 v14, v14, v44
  v_add_f32 v15, v15, v45
  v_lshlrev_b32 v46, 16, v23
  v_and_b32 v47, 0xffff0000, v23
  v_add_f32 v14, v14, v46
  v_add_f32 v15, v15, v47
  v_lshlrev_b32 v44, 16, v24
  v_and_b32 v45, 0xffff0000, v24
  v_add_f32 v16, v16, v44
  v_add_f32 v17, v17, v45
  v_lshlrev_b32 v46, 16, v25
  v_and_b32 v47, 0xffff0000, v25
  v_add_f32 v16, v16, v46
  v_add_f32 v17, v17, v47
  v_lshlrev_b32 v44, 16, v26
  v_and_b32 v45, 0xffff0000, v26
  v_add_f32 v16, v16, v44
  v_add_f32 v17, v17, v45
  v_lshlrev_b32 v46, 16, v27
  v_and_b32 v47, 0xffff0000, v27
  v_add_f32 v16, v16, v46
  v_add_f32 v17, v17, v47
  v_lshlrev_b32 v44, 16, v28
  v_and_b32 v45, 0xffff0000, v28
  v_add_f32 v18, v18, v44
  v_add_f32 v19, v19, v45
  v_lshlrev_b32 v46, 16, v29
  v_and_b32 v47, 0xffff0000, v29
  v_add_f32 v18, v18, v46
  v_add_f32 v19, v19, v47
  v_lshlrev_b32 v44, 16, v30
  v_and_b32 v45, 0xffff0000, v30
  v_add_f32 v18, v18, v44
  v_add_f32 v19, v19, v45
  v_lshlrev_b32 v46, 16, v31
  v_and_b32 v47, 0xffff0000, v31
  v_add_f32 v18, v18, v46
  v_add_f32 v19, v19, v47
  s_waitcnt lgkmcnt(0)
  s_waitcnt vmcnt(14)
  s_barrier
  ds_read_b64_tr_b16 v[20:21], v10 offset:0
  ds_read_b64_tr_b16 v[22:23], v10 offset:768
  ds_read_b64_tr_b16 v[24:25], v10 offset:64
  ds_read_b64_tr_b16 v[26:27], v10 offset:832
  ds_read_b64_tr_b16 v[28:29], v10 offset:128
  ds_read_b64_tr_b16 v[30:31], v10 offset:896
  s_mov_b32 s57, 28672
  v_add_u32 v10, s57, v10
  s_add_u32 m0, s54, 0
  s_mov_b32 s55, 640
  buffer_load_dwordx4 v2, s[12:15], s55 offen lds
  s_add_u32 m0, s54, 4096
  s_mov_b32 s55, 33408
  buffer_load_dwordx4 v2, s[12:15], s55 offen lds
  s_add_u32 m0, s54, 8192
  s_mov_b32 s55, 66176
  buffer_load_dwordx4 v2, s[12:15], s55 offen lds
  s_add_u32 m0, s54, 12288
  s_mov_b32 s55, 98944
  buffer_load_dwordx4 v2, s[12:15], s55 offen lds
  s_add_u32 m0, s54, 16384
  s_mov_b32 s55, 983040
  buffer_load_dwordx4 v3, s[16:19], s55 offen lds
  s_add_u32 m0, s54, 20480
  s_mov_b32 s55, 983040
  buffer_load_dwordx4 v4, s[16:19], s55 offen lds
  s_add_u32 m0, s54, 24576
  s_mov_b32 s55, 983040
  buffer_load_dwordx4 v5, s[16:19], s55 offen lds
  v_lshlrev_b32 v44, 16, v32
  v_and_b32 v45, 0xffff0000, v32
  v_add_f32 v14, v14, v44
  v_add_f32 v15, v15, v45
  v_lshlrev_b32 v46, 16, v33
  v_and_b32 v47, 0xffff0000, v33
  v_add_f32 v14, v14, v46
  v_add_f32 v15, v15, v47
  v_lshlrev_b32 v44, 16, v34
  v_and_b32 v45, 0xffff0000, v34
  v_add_f32 v14, v14, v44
  v_add_f32 v15, v15, v45
  v_lshlrev_b32 v46, 16, v35
  v_and_b32 v47, 0xffff0000, v35
  v_add_f32 v14, v14, v46
  v_add_f32 v15, v15, v47
  v_lshlrev_b32 v44, 16, v36
  v_and_b32 v45, 0xffff0000, v36
  v_add_f32 v16, v16, v44
  v_add_f32 v17, v17, v45
  v_lshlrev_b32 v46, 16, v37
  v_and_b32 v47, 0xffff0000, v37
  v_add_f32 v16, v16, v46
  v_add_f32 v17, v17, v47
  v_lshlrev_b32 v44, 16, v38
  v_and_b32 v45, 0xffff0000, v38
  v_add_f32 v16, v16, v44
  v_add_f32 v17, v17, v45
  v_lshlrev_b32 v46, 16, v39
  v_and_b32 v47, 0xffff0000, v39
  v_add_f32 v16, v16, v46
  v_add_f32 v17, v17, v47
  v_lshlrev_b32 v44, 16, v40
  v_and_b32 v45, 0xffff0000, v40
  v_add_f32 v18, v18, v44
  v_add_f32 v19, v19, v45
  v_lshlrev_b32 v46, 16, v41
  v_and_b32 v47, 0xffff0000, v41
  v_add_f32 v18, v18, v46
  v_add_f32 v19, v19, v47
  v_lshlrev_b32 v44, 16, v42
  v_and_b32 v45, 0xffff0000, v42
  v_add_f32 v18, v18, v44
  v_add_f32 v19, v19, v45
  v_lshlrev_b32 v46, 16, v43
  v_and_b32 v47, 0xffff0000, v43
  v_add_f32 v18, v18, v46
  v_add_f32 v19, v19, v47
  s_waitcnt lgkmcnt(0)
  s_waitcnt vmcnt(14)
  s_barrier
  ds_read_b64_tr_b16 v[32:33], v10 offset:0
  ds_read_b64_tr_b16 v[34:35], v10 offset:768
  ds_read_b64_tr_b16 v[36:37], v10 offset:64
  ds_read_b64_tr_b16 v[38:39], v10 offset:832
  ds_read_b64_tr_b16 v[40:41], v10 offset:128
  ds_read_b64_tr_b16 v[42:43], v10 offset:896
  s_mov_b32 s57, 28672
  v_add_u32 v10, s57, v10
  s_add_u32 m0, s54, 28672
  s_mov_b32 s55, 768
  buffer_load_dwordx4 v2, s[12:15], s55 offen lds
  s_add_u32 m0, s54, 32768
  s_mov_b32 s55, 33536
  buffer_load_dwordx4 v2, s[12:15], s55 offen lds
  s_add_u32 m0, s54, 36864
  s_mov_b32 s55, 66304
  buffer_load_dwordx4 v2, s[12:15], s55 offen lds
  s_add_u32 m0, s54, 40960
  s_mov_b32 s55, 99072
  buffer_load_dwordx4 v2, s[12:15], s55 offen lds
  s_add_u32 m0, s54, 45056
  s_mov_b32 s55, 1179648
  buffer_load_dwordx4 v3, s[16:19], s55 offen lds
  s_add_u32 m0, s54, 49152
  s_mov_b32 s55, 1179648
  buffer_load_dwordx4 v4, s[16:19], s55 offen lds
  s_add_u32 m0, s54, 53248
  s_mov_b32 s55, 1179648
  buffer_load_dwordx4 v5, s[16:19], s55 offen lds
  v_lshlrev_b32 v44, 16, v20
  v_and_b32 v45, 0xffff0000, v20
  v_add_f32 v14, v14, v44
  v_add_f32 v15, v15, v45
  v_lshlrev_b32 v46, 16, v21
  v_and_b32 v47, 0xffff0000, v21
  v_add_f32 v14, v14, v46
  v_add_f32 v15, v15, v47
  v_lshlrev_b32 v44, 16, v22
  v_and_b32 v45, 0xffff0000, v22
  v_add_f32 v14, v14, v44
  v_add_f32 v15, v15, v45
  v_lshlrev_b32 v46, 16, v23
  v_and_b32 v47, 0xffff0000, v23
  v_add_f32 v14, v14, v46
  v_add_f32 v15, v15, v47
  v_lshlrev_b32 v44, 16, v24
  v_and_b32 v45, 0xffff0000, v24
  v_add_f32 v16, v16, v44
  v_add_f32 v17, v17, v45
  v_lshlrev_b32 v46, 16, v25
  v_and_b32 v47, 0xffff0000, v25
  v_add_f32 v16, v16, v46
  v_add_f32 v17, v17, v47
  v_lshlrev_b32 v44, 16, v26
  v_and_b32 v45, 0xffff0000, v26
  v_add_f32 v16, v16, v44
  v_add_f32 v17, v17, v45
  v_lshlrev_b32 v46, 16, v27
  v_and_b32 v47, 0xffff0000, v27
  v_add_f32 v16, v16, v46
  v_add_f32 v17, v17, v47
  v_lshlrev_b32 v44, 16, v28
  v_and_b32 v45, 0xffff0000, v28
  v_add_f32 v18, v18, v44
  v_add_f32 v19, v19, v45
  v_lshlrev_b32 v46, 16, v29
  v_and_b32 v47, 0xffff0000, v29
  v_add_f32 v18, v18, v46
  v_add_f32 v19, v19, v47
  v_lshlrev_b32 v44, 16, v30
  v_and_b32 v45, 0xffff0000, v30
  v_add_f32 v18, v18, v44
  v_add_f32 v19, v19, v45
  v_lshlrev_b32 v46, 16, v31
  v_and_b32 v47, 0xffff0000, v31
  v_add_f32 v18, v18, v46
  v_add_f32 v19, v19, v47
  s_waitcnt lgkmcnt(0)
  s_waitcnt vmcnt(14)
  s_barrier
  ds_read_b64_tr_b16 v[20:21], v10 offset:0
  ds_read_b64_tr_b16 v[22:23], v10 offset:768
  ds_read_b64_tr_b16 v[24:25], v10 offset:64
  ds_read_b64_tr_b16 v[26:27], v10 offset:832
  ds_read_b64_tr_b16 v[28:29], v10 offset:128
  ds_read_b64_tr_b16 v[30:31], v10 offset:896
  s_mov_b32 s57, 4294852608
  v_add_u32 v10, s57, v10
  s_add_u32 m0, s54, 57344
  s_mov_b32 s55, 896
  buffer_load_dwordx4 v2, s[12:15], s55 offen lds
  s_add_u32 m0, s54, 61440
  s_mov_b32 s55, 33664
  buffer_load_dwordx4 v2, s[12:15], s55 offen lds
  s_add_u32 m0, s54, 65536
  s_mov_b32 s55, 66432
  buffer_load_dwordx4 v2, s[12:15], s55 offen lds
  s_add_u32 m0, s54, 69632
  s_mov_b32 s55, 99200
  buffer_load_dwordx4 v2, s[12:15], s55 offen lds
  s_add_u32 m0, s54, 73728
  s_mov_b32 s55, 1376256
  buffer_load_dwordx4 v3, s[16:19], s55 offen lds
  s_add_u32 m0, s54, 77824
  s_mov_b32 s55, 1376256
  buffer_load_dwordx4 v4, s[16:19], s55 offen lds
  s_add_u32 m0, s54, 81920
  s_mov_b32 s55, 1376256
  buffer_load_dwordx4 v5, s[16:19], s55 offen lds
  v_lshlrev_b32 v44, 16, v32
  v_and_b32 v45, 0xffff0000, v32
  v_add_f32 v14, v14, v44
  v_add_f32 v15, v15, v45
  v_lshlrev_b32 v46, 16, v33
  v_and_b32 v47, 0xffff0000, v33
  v_add_f32 v14, v14, v46
  v_add_f32 v15, v15, v47
  v_lshlrev_b32 v44, 16, v34
  v_and_b32 v45, 0xffff0000, v34
  v_add_f32 v14, v14, v44
  v_add_f32 v15, v15, v45
  v_lshlrev_b32 v46, 16, v35
  v_and_b32 v47, 0xffff0000, v35
  v_add_f32 v14, v14, v46
  v_add_f32 v15, v15, v47
  v_lshlrev_b32 v44, 16, v36
  v_and_b32 v45, 0xffff0000, v36
  v_add_f32 v16, v16, v44
  v_add_f32 v17, v17, v45
  v_lshlrev_b32 v46, 16, v37
  v_and_b32 v47, 0xffff0000, v37
  v_add_f32 v16, v16, v46
  v_add_f32 v17, v17, v47
  v_lshlrev_b32 v44, 16, v38
  v_and_b32 v45, 0xffff0000, v38
  v_add_f32 v16, v16, v44
  v_add_f32 v17, v17, v45
  v_lshlrev_b32 v46, 16, v39
  v_and_b32 v47, 0xffff0000, v39
  v_add_f32 v16, v16, v46
  v_add_f32 v17, v17, v47
  v_lshlrev_b32 v44, 16, v40
  v_and_b32 v45, 0xffff0000, v40
  v_add_f32 v18, v18, v44
  v_add_f32 v19, v19, v45
  v_lshlrev_b32 v46, 16, v41
  v_and_b32 v47, 0xffff0000, v41
  v_add_f32 v18, v18, v46
  v_add_f32 v19, v19, v47
  v_lshlrev_b32 v44, 16, v42
  v_and_b32 v45, 0xffff0000, v42
  v_add_f32 v18, v18, v44
  v_add_f32 v19, v19, v45
  v_lshlrev_b32 v46, 16, v43
  v_and_b32 v47, 0xffff0000, v43
  v_add_f32 v18, v18, v46
  v_add_f32 v19, v19, v47
  s_waitcnt lgkmcnt(0)
  s_waitcnt vmcnt(14)
  s_barrier
  ds_read_b64_tr_b16 v[32:33], v10 offset:0
  ds_read_b64_tr_b16 v[34:35], v10 offset:768
  ds_read_b64_tr_b16 v[36:37], v10 offset:64
  ds_read_b64_tr_b16 v[38:39], v10 offset:832
  ds_read_b64_tr_b16 v[40:41], v10 offset:128
  ds_read_b64_tr_b16 v[42:43], v10 offset:896
  s_mov_b32 s57, 28672
  v_add_u32 v10, s57, v10
  v_lshlrev_b32 v44, 16, v20
  v_and_b32 v45, 0xffff0000, v20
  v_add_f32 v14, v14, v44
  v_add_f32 v15, v15, v45
  v_lshlrev_b32 v46, 16, v21
  v_and_b32 v47, 0xffff0000, v21
  v_add_f32 v14, v14, v46
  v_add_f32 v15, v15, v47
  v_lshlrev_b32 v44, 16, v22
  v_and_b32 v45, 0xffff0000, v22
  v_add_f32 v14, v14, v44
  v_add_f32 v15, v15, v45
  v_lshlrev_b32 v46, 16, v23
  v_and_b32 v47, 0xffff0000, v23
  v_add_f32 v14, v14, v46
  v_add_f32 v15, v15, v47
  v_lshlrev_b32 v44, 16, v24
  v_and_b32 v45, 0xffff0000, v24
  v_add_f32 v16, v16, v44
  v_add_f32 v17, v17, v45
  v_lshlrev_b32 v46, 16, v25
  v_and_b32 v47, 0xffff0000, v25
  v_add_f32 v16, v16, v46
  v_add_f32 v17, v17, v47
  v_lshlrev_b32 v44, 16, v26
  v_and_b32 v45, 0xffff0000, v26
  v_add_f32 v16, v16, v44
  v_add_f32 v17, v17, v45
  v_lshlrev_b32 v46, 16, v27
  v_and_b32 v47, 0xffff0000, v27
  v_add_f32 v16, v16, v46
  v_add_f32 v17, v17, v47
  v_lshlrev_b32 v44, 16, v28
  v_and_b32 v45, 0xffff0000, v28
  v_add_f32 v18, v18, v44
  v_add_f32 v19, v19, v45
  v_lshlrev_b32 v46, 16, v29
  v_and_b32 v47, 0xffff0000, v29
  v_add_f32 v18, v18, v46
  v_add_f32 v19, v19, v47
  v_lshlrev_b32 v44, 16, v30
  v_and_b32 v45, 0xffff0000, v30
  v_add_f32 v18, v18, v44
  v_add_f32 v19, v19, v45
  v_lshlrev_b32 v46, 16, v31
  v_and_b32 v47, 0xffff0000, v31
  v_add_f32 v18, v18, v46
  v_add_f32 v19, v19, v47
  s_waitcnt lgkmcnt(0)
  v_lshlrev_b32 v44, 16, v32
  v_and_b32 v45, 0xffff0000, v32
  v_add_f32 v14, v14, v44
  v_add_f32 v15, v15, v45
  v_lshlrev_b32 v46, 16, v33
  v_and_b32 v47, 0xffff0000, v33
  v_add_f32 v14, v14, v46
  v_add_f32 v15, v15, v47
  v_lshlrev_b32 v44, 16, v34
  v_and_b32 v45, 0xffff0000, v34
  v_add_f32 v14, v14, v44
  v_add_f32 v15, v15, v45
  v_lshlrev_b32 v46, 16, v35
  v_and_b32 v47, 0xffff0000, v35
  v_add_f32 v14, v14, v46
  v_add_f32 v15, v15, v47
  v_lshlrev_b32 v44, 16, v36
  v_and_b32 v45, 0xffff0000, v36
  v_add_f32 v16, v16, v44
  v_add_f32 v17, v17, v45
  v_lshlrev_b32 v46, 16, v37
  v_and_b32 v47, 0xffff0000, v37
  v_add_f32 v16, v16, v46
  v_add_f32 v17, v17, v47
  v_lshlrev_b32 v44, 16, v38
  v_and_b32 v45, 0xffff0000, v38
  v_add_f32 v16, v16, v44
  v_add_f32 v17, v17, v45
  v_lshlrev_b32 v46, 16, v39
  v_and_b32 v47, 0xffff0000, v39
  v_add_f32 v16, v16, v46
  v_add_f32 v17, v17, v47
  v_lshlrev_b32 v44, 16, v40
  v_and_b32 v45, 0xffff0000, v40
  v_add_f32 v18, v18, v44
  v_add_f32 v19, v19, v45
  v_lshlrev_b32 v46, 16, v41
  v_and_b32 v47, 0xffff0000, v41
  v_add_f32 v18, v18, v46
  v_add_f32 v19, v19, v47
  v_lshlrev_b32 v44, 16, v42
  v_and_b32 v45, 0xffff0000, v42
  v_add_f32 v18, v18, v44
  v_add_f32 v19, v19, v45
  v_lshlrev_b32 v46, 16, v43
  v_and_b32 v47, 0xffff0000, v43
  v_add_f32 v18, v18, v46
  v_add_f32 v19, v19, v47
  s_waitcnt vmcnt(7)
  s_barrier
  ds_read_b64_tr_b16 v[20:21], v10 offset:0
  ds_read_b64_tr_b16 v[22:23], v10 offset:768
  ds_read_b64_tr_b16 v[24:25], v10 offset:64
  ds_read_b64_tr_b16 v[26:27], v10 offset:832
  ds_read_b64_tr_b16 v[28:29], v10 offset:128
  ds_read_b64_tr_b16 v[30:31], v10 offset:896
  s_mov_b32 s57, 28672
  v_add_u32 v10, s57, v10
  s_waitcnt lgkmcnt(0)
  v_lshlrev_b32 v44, 16, v20
  v_and_b32 v45, 0xffff0000, v20
  v_add_f32 v14, v14, v44
  v_add_f32 v15, v15, v45
  v_lshlrev_b32 v46, 16, v21
  v_and_b32 v47, 0xffff0000, v21
  v_add_f32 v14, v14, v46
  v_add_f32 v15, v15, v47
  v_lshlrev_b32 v44, 16, v22
  v_and_b32 v45, 0xffff0000, v22
  v_add_f32 v14, v14, v44
  v_add_f32 v15, v15, v45
  v_lshlrev_b32 v46, 16, v23
  v_and_b32 v47, 0xffff0000, v23
  v_add_f32 v14, v14, v46
  v_add_f32 v15, v15, v47
  v_lshlrev_b32 v44, 16, v24
  v_and_b32 v45, 0xffff0000, v24
  v_add_f32 v16, v16, v44
  v_add_f32 v17, v17, v45
  v_lshlrev_b32 v46, 16, v25
  v_and_b32 v47, 0xffff0000, v25
  v_add_f32 v16, v16, v46
  v_add_f32 v17, v17, v47
  v_lshlrev_b32 v44, 16, v26
  v_and_b32 v45, 0xffff0000, v26
  v_add_f32 v16, v16, v44
  v_add_f32 v17, v17, v45
  v_lshlrev_b32 v46, 16, v27
  v_and_b32 v47, 0xffff0000, v27
  v_add_f32 v16, v16, v46
  v_add_f32 v17, v17, v47
  v_lshlrev_b32 v44, 16, v28
  v_and_b32 v45, 0xffff0000, v28
  v_add_f32 v18, v18, v44
  v_add_f32 v19, v19, v45
  v_lshlrev_b32 v46, 16, v29
  v_and_b32 v47, 0xffff0000, v29
  v_add_f32 v18, v18, v46
  v_add_f32 v19, v19, v47
  v_lshlrev_b32 v44, 16, v30
  v_and_b32 v45, 0xffff0000, v30
  v_add_f32 v18, v18, v44
  v_add_f32 v19, v19, v45
  v_lshlrev_b32 v46, 16, v31
  v_and_b32 v47, 0xffff0000, v31
  v_add_f32 v18, v18, v46
  v_add_f32 v19, v19, v47
  s_waitcnt vmcnt(0)
  s_barrier
  ds_read_b64_tr_b16 v[32:33], v10 offset:0
  ds_read_b64_tr_b16 v[34:35], v10 offset:768
  ds_read_b64_tr_b16 v[36:37], v10 offset:64
  ds_read_b64_tr_b16 v[38:39], v10 offset:832
  ds_read_b64_tr_b16 v[40:41], v10 offset:128
  ds_read_b64_tr_b16 v[42:43], v10 offset:896
  s_mov_b32 s57, 28672
  v_add_u32 v10, s57, v10
  s_waitcnt lgkmcnt(0)
  v_lshlrev_b32 v44, 16, v32
  v_and_b32 v45, 0xffff0000, v32
  v_add_f32 v14, v14, v44
  v_add_f32 v15, v15, v45
  v_lshlrev_b32 v46, 16, v33
  v_and_b32 v47, 0xffff0000, v33
  v_add_f32 v14, v14, v46
  v_add_f32 v15, v15, v47
  v_lshlrev_b32 v44, 16, v34
  v_and_b32 v45, 0xffff0000, v34
  v_add_f32 v14, v14, v44
  v_add_f32 v15, v15, v45
  v_lshlrev_b32 v46, 16, v35
  v_and_b32 v47, 0xffff0000, v35
  v_add_f32 v14, v14, v46
  v_add_f32 v15, v15, v47
  v_lshlrev_b32 v44, 16, v36
  v_and_b32 v45, 0xffff0000, v36
  v_add_f32 v16, v16, v44
  v_add_f32 v17, v17, v45
  v_lshlrev_b32 v46, 16, v37
  v_and_b32 v47, 0xffff0000, v37
  v_add_f32 v16, v16, v46
  v_add_f32 v17, v17, v47
  v_lshlrev_b32 v44, 16, v38
  v_and_b32 v45, 0xffff0000, v38
  v_add_f32 v16, v16, v44
  v_add_f32 v17, v17, v45
  v_lshlrev_b32 v46, 16, v39
  v_and_b32 v47, 0xffff0000, v39
  v_add_f32 v16, v16, v46
  v_add_f32 v17, v17, v47
  v_lshlrev_b32 v44, 16, v40
  v_and_b32 v45, 0xffff0000, v40
  v_add_f32 v18, v18, v44
  v_add_f32 v19, v19, v45
  v_lshlrev_b32 v46, 16, v41
  v_and_b32 v47, 0xffff0000, v41
  v_add_f32 v18, v18, v46
  v_add_f32 v19, v19, v47
  v_lshlrev_b32 v44, 16, v42
  v_and_b32 v45, 0xffff0000, v42
  v_add_f32 v18, v18, v44
  v_add_f32 v19, v19, v45
  v_lshlrev_b32 v46, 16, v43
  v_and_b32 v47, 0xffff0000, v43
  v_add_f32 v18, v18, v46
  v_add_f32 v19, v19, v47
  s_nop 2
  v_and_b32 v11, 31, v0
  v_lshlrev_b32 v11, 2, v11
  v_add_u32 v11, 143360, v11
  v_add_f32 v14, v14, v15
  v_mov_b32 v15, v14
  v_add_f32 v16, v16, v17
  v_mov_b32 v17, v16
  v_add_f32 v18, v18, v19
  v_mov_b32 v19, v18
  s_nop 1
  v_permlane32_swap_b32 v14, v15
  v_permlane32_swap_b32 v16, v17
  v_permlane32_swap_b32 v18, v19
  s_nop 1
  v_add_f32 v14, v14, v15
  v_add_f32 v16, v16, v17
  v_add_f32 v18, v18, v19
  s_mul_i32 s56, s48, 384
  s_add_u32 s56, s56, 1536
  v_add_u32 v12, s56, v11
  ds_write_b32 v12, v14 offset:0
  ds_write_b32 v12, v16 offset:128
  ds_write_b32 v12, v18 offset:256
  s_waitcnt lgkmcnt(0)
  s_barrier
  s_cmp_eq_u32 s48, 3
  s_cbranch_scc1 sequential_preLN__mha_block__dense_activation_squared_relu__prompt_kernel_cf_34
  s_lshl_b32 s56, s48, 7
  v_add_u32 v12, s56, v11
  ds_read_b32 v20, v12 offset:1536
  ds_read_b32 v21, v12 offset:1920
  ds_read_b32 v22, v12 offset:2304
  ds_read_b32 v23, v12 offset:2688
  s_waitcnt lgkmcnt(0)
  v_add_f32 v20, v20, v21
  v_add_f32 v22, v22, v23
  v_add_f32 v20, v20, v22
  ds_write_b32 v12, v20
  s_waitcnt lgkmcnt(0)
sequential_preLN__mha_block__dense_activation_squared_relu__prompt_kernel_cf_34:
  s_barrier
  s_branch sequential_preLN__mha_block__dense_activation_squared_relu__prompt_kernel_A_join
sequential_preLN__mha_block__dense_activation_squared_relu__prompt_kernel_hb_33:
  s_waitcnt vmcnt(14)
  s_barrier
  ds_read_b64_tr_b16 v[20:21], v10 offset:0
  ds_read_b64_tr_b16 v[22:23], v10 offset:768
  ds_read_b64_tr_b16 v[24:25], v10 offset:64
  ds_read_b64_tr_b16 v[26:27], v10 offset:832
  ds_read_b64_tr_b16 v[28:29], v10 offset:128
  ds_read_b64_tr_b16 v[30:31], v10 offset:896
  s_mov_b32 s57, 28672
  v_add_u32 v10, s57, v10
  s_add_u32 m0, s54, 86016
  s_mov_b32 s55, 384
  buffer_load_dwordx4 v2, s[12:15], s55 offen lds
  s_add_u32 m0, s54, 90112
  s_mov_b32 s55, 33152
  buffer_load_dwordx4 v2, s[12:15], s55 offen lds
  s_add_u32 m0, s54, 94208
  s_mov_b32 s55, 65920
  buffer_load_dwordx4 v2, s[12:15], s55 offen lds
  s_add_u32 m0, s54, 98304
  s_mov_b32 s55, 98688
  buffer_load_dwordx4 v2, s[12:15], s55 offen lds
  s_add_u32 m0, s54, 102400
  s_mov_b32 s55, 589824
  buffer_load_dwordx4 v3, s[16:19], s55 offen lds
  s_add_u32 m0, s54, 106496
  s_mov_b32 s55, 589824
  buffer_load_dwordx4 v4, s[16:19], s55 offen lds
  s_add_u32 m0, s54, 110592
  s_mov_b32 s55, 589824
  buffer_load_dwordx4 v5, s[16:19], s55 offen lds
  s_waitcnt lgkmcnt(0)
  s_waitcnt vmcnt(14)
  s_barrier
  ds_read_b64_tr_b16 v[32:33], v10 offset:0
  ds_read_b64_tr_b16 v[34:35], v10 offset:768
  ds_read_b64_tr_b16 v[36:37], v10 offset:64
  ds_read_b64_tr_b16 v[38:39], v10 offset:832
  ds_read_b64_tr_b16 v[40:41], v10 offset:128
  ds_read_b64_tr_b16 v[42:43], v10 offset:896
  s_mov_b32 s57, 28672
  v_add_u32 v10, s57, v10
  v_lshlrev_b32 v44, 16, v20
  v_and_b32 v45, 0xffff0000, v20
  v_add_f32 v14, v14, v44
  v_add_f32 v15, v15, v45
  v_lshlrev_b32 v46, 16, v21
  v_and_b32 v47, 0xffff0000, v21
  v_add_f32 v14, v14, v46
  v_add_f32 v15, v15, v47
  v_lshlrev_b32 v44, 16, v22
  v_and_b32 v45, 0xffff0000, v22
  v_add_f32 v14, v14, v44
  v_add_f32 v15, v15, v45
  v_lshlrev_b32 v46, 16, v23
  v_and_b32 v47, 0xffff0000, v23
  v_add_f32 v14, v14, v46
  v_add_f32 v15, v15, v47
  v_lshlrev_b32 v44, 16, v24
  v_and_b32 v45, 0xffff0000, v24
  v_add_f32 v16, v16, v44
  v_add_f32 v17, v17, v45
  v_lshlrev_b32 v46, 16, v25
  v_and_b32 v47, 0xffff0000, v25
  v_add_f32 v16, v16, v46
  v_add_f32 v17, v17, v47
  v_lshlrev_b32 v44, 16, v26
  v_and_b32 v45, 0xffff0000, v26
  v_add_f32 v16, v16, v44
  v_add_f32 v17, v17, v45
  v_lshlrev_b32 v46, 16, v27
  v_and_b32 v47, 0xffff0000, v27
  v_add_f32 v16, v16, v46
  v_add_f32 v17, v17, v47
  v_lshlrev_b32 v44, 16, v28
  v_and_b32 v45, 0xffff0000, v28
  v_add_f32 v18, v18, v44
  v_add_f32 v19, v19, v45
  v_lshlrev_b32 v46, 16, v29
  v_and_b32 v47, 0xffff0000, v29
  v_add_f32 v18, v18, v46
  v_add_f32 v19, v19, v47
  v_lshlrev_b32 v44, 16, v30
  v_and_b32 v45, 0xffff0000, v30
  v_add_f32 v18, v18, v44
  v_add_f32 v19, v19, v45
  v_lshlrev_b32 v46, 16, v31
  v_and_b32 v47, 0xffff0000, v31
  v_add_f32 v18, v18, v46
  v_add_f32 v19, v19, v47
  s_add_u32 m0, s54, 114688
  s_mov_b32 s55, 512
  buffer_load_dwordx4 v2, s[12:15], s55 offen lds
  s_add_u32 m0, s54, 118784
  s_mov_b32 s55, 33280
  buffer_load_dwordx4 v2, s[12:15], s55 offen lds
  s_add_u32 m0, s54, 122880
  s_mov_b32 s55, 66048
  buffer_load_dwordx4 v2, s[12:15], s55 offen lds
  s_add_u32 m0, s54, 126976
  s_mov_b32 s55, 98816
  buffer_load_dwordx4 v2, s[12:15], s55 offen lds
  s_add_u32 m0, s54, 131072
  s_mov_b32 s55, 786432
  buffer_load_dwordx4 v3, s[16:19], s55 offen lds
  s_add_u32 m0, s54, 135168
  s_mov_b32 s55, 786432
  buffer_load_dwordx4 v4, s[16:19], s55 offen lds
  s_add_u32 m0, s54, 139264
  s_mov_b32 s55, 786432
  buffer_load_dwordx4 v5, s[16:19], s55 offen lds
  s_waitcnt lgkmcnt(0)
  s_waitcnt vmcnt(14)
  s_barrier
  ds_read_b64_tr_b16 v[20:21], v10 offset:0
  ds_read_b64_tr_b16 v[22:23], v10 offset:768
  ds_read_b64_tr_b16 v[24:25], v10 offset:64
  ds_read_b64_tr_b16 v[26:27], v10 offset:832
  ds_read_b64_tr_b16 v[28:29], v10 offset:128
  ds_read_b64_tr_b16 v[30:31], v10 offset:896
  s_mov_b32 s57, 28672
  v_add_u32 v10, s57, v10
  v_lshlrev_b32 v44, 16, v32
  v_and_b32 v45, 0xffff0000, v32
  v_add_f32 v14, v14, v44
  v_add_f32 v15, v15, v45
  v_lshlrev_b32 v46, 16, v33
  v_and_b32 v47, 0xffff0000, v33
  v_add_f32 v14, v14, v46
  v_add_f32 v15, v15, v47
  v_lshlrev_b32 v44, 16, v34
  v_and_b32 v45, 0xffff0000, v34
  v_add_f32 v14, v14, v44
  v_add_f32 v15, v15, v45
  v_lshlrev_b32 v46, 16, v35
  v_and_b32 v47, 0xffff0000, v35
  v_add_f32 v14, v14, v46
  v_add_f32 v15, v15, v47
  v_lshlrev_b32 v44, 16, v36
  v_and_b32 v45, 0xffff0000, v36
  v_add_f32 v16, v16, v44
  v_add_f32 v17, v17, v45
  v_lshlrev_b32 v46, 16, v37
  v_and_b32 v47, 0xffff0000, v37
  v_add_f32 v16, v16, v46
  v_add_f32 v17, v17, v47
  v_lshlrev_b32 v44, 16, v38
  v_and_b32 v45, 0xffff0000, v38
  v_add_f32 v16, v16, v44
  v_add_f32 v17, v17, v45
  v_lshlrev_b32 v46, 16, v39
  v_and_b32 v47, 0xffff0000, v39
  v_add_f32 v16, v16, v46
  v_add_f32 v17, v17, v47
  v_lshlrev_b32 v44, 16, v40
  v_and_b32 v45, 0xffff0000, v40
  v_add_f32 v18, v18, v44
  v_add_f32 v19, v19, v45
  v_lshlrev_b32 v46, 16, v41
  v_and_b32 v47, 0xffff0000, v41
  v_add_f32 v18, v18, v46
  v_add_f32 v19, v19, v47
  v_lshlrev_b32 v44, 16, v42
  v_and_b32 v45, 0xffff0000, v42
  v_add_f32 v18, v18, v44
  v_add_f32 v19, v19, v45
  v_lshlrev_b32 v46, 16, v43
  v_and_b32 v47, 0xffff0000, v43
  v_add_f32 v18, v18, v46
  v_add_f32 v19, v19, v47
  s_add_u32 m0, s54, 0
  s_mov_b32 s55, 640
  buffer_load_dwordx4 v2, s[12:15], s55 offen lds
  s_add_u32 m0, s54, 4096
  s_mov_b32 s55, 33408
  buffer_load_dwordx4 v2, s[12:15], s55 offen lds
  s_add_u32 m0, s54, 8192
  s_mov_b32 s55, 66176
  buffer_load_dwordx4 v2, s[12:15], s55 offen lds
  s_add_u32 m0, s54, 12288
  s_mov_b32 s55, 98944
  buffer_load_dwordx4 v2, s[12:15], s55 offen lds
  s_add_u32 m0, s54, 16384
  s_mov_b32 s55, 983040
  buffer_load_dwordx4 v3, s[16:19], s55 offen lds
  s_add_u32 m0, s54, 20480
  s_mov_b32 s55, 983040
  buffer_load_dwordx4 v4, s[16:19], s55 offen lds
  s_add_u32 m0, s54, 24576
  s_mov_b32 s55, 983040
  buffer_load_dwordx4 v5, s[16:19], s55 offen lds
  s_waitcnt lgkmcnt(0)
  s_waitcnt vmcnt(14)
  s_barrier
  ds_read_b64_tr_b16 v[32:33], v10 offset:0
  ds_read_b64_tr_b16 v[34:35], v10 offset:768
  ds_read_b64_tr_b16 v[36:37], v10 offset:64
  ds_read_b64_tr_b16 v[38:39], v10 offset:832
  ds_read_b64_tr_b16 v[40:41], v10 offset:128
  ds_read_b64_tr_b16 v[42:43], v10 offset:896
  s_mov_b32 s57, 28672
  v_add_u32 v10, s57, v10
  v_lshlrev_b32 v44, 16, v20
  v_and_b32 v45, 0xffff0000, v20
  v_add_f32 v14, v14, v44
  v_add_f32 v15, v15, v45
  v_lshlrev_b32 v46, 16, v21
  v_and_b32 v47, 0xffff0000, v21
  v_add_f32 v14, v14, v46
  v_add_f32 v15, v15, v47
  v_lshlrev_b32 v44, 16, v22
  v_and_b32 v45, 0xffff0000, v22
  v_add_f32 v14, v14, v44
  v_add_f32 v15, v15, v45
  v_lshlrev_b32 v46, 16, v23
  v_and_b32 v47, 0xffff0000, v23
  v_add_f32 v14, v14, v46
  v_add_f32 v15, v15, v47
  v_lshlrev_b32 v44, 16, v24
  v_and_b32 v45, 0xffff0000, v24
  v_add_f32 v16, v16, v44
  v_add_f32 v17, v17, v45
  v_lshlrev_b32 v46, 16, v25
  v_and_b32 v47, 0xffff0000, v25
  v_add_f32 v16, v16, v46
  v_add_f32 v17, v17, v47
  v_lshlrev_b32 v44, 16, v26
  v_and_b32 v45, 0xffff0000, v26
  v_add_f32 v16, v16, v44
  v_add_f32 v17, v17, v45
  v_lshlrev_b32 v46, 16, v27
  v_and_b32 v47, 0xffff0000, v27
  v_add_f32 v16, v16, v46
  v_add_f32 v17, v17, v47
  v_lshlrev_b32 v44, 16, v28
  v_and_b32 v45, 0xffff0000, v28
  v_add_f32 v18, v18, v44
  v_add_f32 v19, v19, v45
  v_lshlrev_b32 v46, 16, v29
  v_and_b32 v47, 0xffff0000, v29
  v_add_f32 v18, v18, v46
  v_add_f32 v19, v19, v47
  v_lshlrev_b32 v44, 16, v30
  v_and_b32 v45, 0xffff0000, v30
  v_add_f32 v18, v18, v44
  v_add_f32 v19, v19, v45
  v_lshlrev_b32 v46, 16, v31
  v_and_b32 v47, 0xffff0000, v31
  v_add_f32 v18, v18, v46
  v_add_f32 v19, v19, v47
  s_add_u32 m0, s54, 28672
  s_mov_b32 s55, 768
  buffer_load_dwordx4 v2, s[12:15], s55 offen lds
  s_add_u32 m0, s54, 32768
  s_mov_b32 s55, 33536
  buffer_load_dwordx4 v2, s[12:15], s55 offen lds
  s_add_u32 m0, s54, 36864
  s_mov_b32 s55, 66304
  buffer_load_dwordx4 v2, s[12:15], s55 offen lds
  s_add_u32 m0, s54, 40960
  s_mov_b32 s55, 99072
  buffer_load_dwordx4 v2, s[12:15], s55 offen lds
  s_add_u32 m0, s54, 45056
  s_mov_b32 s55, 1179648
  buffer_load_dwordx4 v3, s[16:19], s55 offen lds
  s_add_u32 m0, s54, 49152
  s_mov_b32 s55, 1179648
  buffer_load_dwordx4 v4, s[16:19], s55 offen lds
  s_add_u32 m0, s54, 53248
  s_mov_b32 s55, 1179648
  buffer_load_dwordx4 v5, s[16:19], s55 offen lds
  s_waitcnt lgkmcnt(0)
  s_waitcnt vmcnt(14)
  s_barrier
  ds_read_b64_tr_b16 v[20:21], v10 offset:0
  ds_read_b64_tr_b16 v[22:23], v10 offset:768
  ds_read_b64_tr_b16 v[24:25], v10 offset:64
  ds_read_b64_tr_b16 v[26:27], v10 offset:832
  ds_read_b64_tr_b16 v[28:29], v10 offset:128
  ds_read_b64_tr_b16 v[30:31], v10 offset:896
  s_mov_b32 s57, 4294852608
  v_add_u32 v10, s57, v10
  v_lshlrev_b32 v44, 16, v32
  v_and_b32 v45, 0xffff0000, v32
  v_add_f32 v14, v14, v44
  v_add_f32 v15, v15, v45
  v_lshlrev_b32 v46, 16, v33
  v_and_b32 v47, 0xffff0000, v33
  v_add_f32 v14, v14, v46
  v_add_f32 v15, v15, v47
  v_lshlrev_b32 v44, 16, v34
  v_and_b32 v45, 0xffff0000, v34
  v_add_f32 v14, v14, v44
  v_add_f32 v15, v15, v45
  v_lshlrev_b32 v46, 16, v35
  v_and_b32 v47, 0xffff0000, v35
  v_add_f32 v14, v14, v46
  v_add_f32 v15, v15, v47
  v_lshlrev_b32 v44, 16, v36
  v_and_b32 v45, 0xffff0000, v36
  v_add_f32 v16, v16, v44
  v_add_f32 v17, v17, v45
  v_lshlrev_b32 v46, 16, v37
  v_and_b32 v47, 0xffff0000, v37
  v_add_f32 v16, v16, v46
  v_add_f32 v17, v17, v47
  v_lshlrev_b32 v44, 16, v38
  v_and_b32 v45, 0xffff0000, v38
  v_add_f32 v16, v16, v44
  v_add_f32 v17, v17, v45
  v_lshlrev_b32 v46, 16, v39
  v_and_b32 v47, 0xffff0000, v39
  v_add_f32 v16, v16, v46
  v_add_f32 v17, v17, v47
  v_lshlrev_b32 v44, 16, v40
  v_and_b32 v45, 0xffff0000, v40
  v_add_f32 v18, v18, v44
  v_add_f32 v19, v19, v45
  v_lshlrev_b32 v46, 16, v41
  v_and_b32 v47, 0xffff0000, v41
  v_add_f32 v18, v18, v46
  v_add_f32 v19, v19, v47
  v_lshlrev_b32 v44, 16, v42
  v_and_b32 v45, 0xffff0000, v42
  v_add_f32 v18, v18, v44
  v_add_f32 v19, v19, v45
  v_lshlrev_b32 v46, 16, v43
  v_and_b32 v47, 0xffff0000, v43
  v_add_f32 v18, v18, v46
  v_add_f32 v19, v19, v47
  s_add_u32 m0, s54, 57344
  s_mov_b32 s55, 896
  buffer_load_dwordx4 v2, s[12:15], s55 offen lds
  s_add_u32 m0, s54, 61440
  s_mov_b32 s55, 33664
  buffer_load_dwordx4 v2, s[12:15], s55 offen lds
  s_add_u32 m0, s54, 65536
  s_mov_b32 s55, 66432
  buffer_load_dwordx4 v2, s[12:15], s55 offen lds
  s_add_u32 m0, s54, 69632
  s_mov_b32 s55, 99200
  buffer_load_dwordx4 v2, s[12:15], s55 offen lds
  s_add_u32 m0, s54, 73728
  s_mov_b32 s55, 1376256
  buffer_load_dwordx4 v3, s[16:19], s55 offen lds
  s_add_u32 m0, s54, 77824
  s_mov_b32 s55, 1376256
  buffer_load_dwordx4 v4, s[16:19], s55 offen lds
  s_add_u32 m0, s54, 81920
  s_mov_b32 s55, 1376256
  buffer_load_dwordx4 v5, s[16:19], s55 offen lds
  s_waitcnt lgkmcnt(0)
  s_waitcnt vmcnt(14)
  s_barrier
  ds_read_b64_tr_b16 v[32:33], v10 offset:0
  ds_read_b64_tr_b16 v[34:35], v10 offset:768
  ds_read_b64_tr_b16 v[36:37], v10 offset:64
  ds_read_b64_tr_b16 v[38:39], v10 offset:832
  ds_read_b64_tr_b16 v[40:41], v10 offset:128
  ds_read_b64_tr_b16 v[42:43], v10 offset:896
  s_mov_b32 s57, 28672
  v_add_u32 v10, s57, v10
  v_lshlrev_b32 v44, 16, v20
  v_and_b32 v45, 0xffff0000, v20
  v_add_f32 v14, v14, v44
  v_add_f32 v15, v15, v45
  v_lshlrev_b32 v46, 16, v21
  v_and_b32 v47, 0xffff0000, v21
  v_add_f32 v14, v14, v46
  v_add_f32 v15, v15, v47
  v_lshlrev_b32 v44, 16, v22
  v_and_b32 v45, 0xffff0000, v22
  v_add_f32 v14, v14, v44
  v_add_f32 v15, v15, v45
  v_lshlrev_b32 v46, 16, v23
  v_and_b32 v47, 0xffff0000, v23
  v_add_f32 v14, v14, v46
  v_add_f32 v15, v15, v47
  v_lshlrev_b32 v44, 16, v24
  v_and_b32 v45, 0xffff0000, v24
  v_add_f32 v16, v16, v44
  v_add_f32 v17, v17, v45
  v_lshlrev_b32 v46, 16, v25
  v_and_b32 v47, 0xffff0000, v25
  v_add_f32 v16, v16, v46
  v_add_f32 v17, v17, v47
  v_lshlrev_b32 v44, 16, v26
  v_and_b32 v45, 0xffff0000, v26
  v_add_f32 v16, v16, v44
  v_add_f32 v17, v17, v45
  v_lshlrev_b32 v46, 16, v27
  v_and_b32 v47, 0xffff0000, v27
  v_add_f32 v16, v16, v46
  v_add_f32 v17, v17, v47
  v_lshlrev_b32 v44, 16, v28
  v_and_b32 v45, 0xffff0000, v28
  v_add_f32 v18, v18, v44
  v_add_f32 v19, v19, v45
  v_lshlrev_b32 v46, 16, v29
  v_and_b32 v47, 0xffff0000, v29
  v_add_f32 v18, v18, v46
  v_add_f32 v19, v19, v47
  v_lshlrev_b32 v44, 16, v30
  v_and_b32 v45, 0xffff0000, v30
  v_add_f32 v18, v18, v44
  v_add_f32 v19, v19, v45
  v_lshlrev_b32 v46, 16, v31
  v_and_b32 v47, 0xffff0000, v31
  v_add_f32 v18, v18, v46
  v_add_f32 v19, v19, v47
  s_waitcnt lgkmcnt(0)
  v_lshlrev_b32 v44, 16, v32
  v_and_b32 v45, 0xffff0000, v32
  v_add_f32 v14, v14, v44
  v_add_f32 v15, v15, v45
  v_lshlrev_b32 v46, 16, v33
  v_and_b32 v47, 0xffff0000, v33
  v_add_f32 v14, v14, v46
  v_add_f32 v15, v15, v47
  v_lshlrev_b32 v44, 16, v34
  v_and_b32 v45, 0xffff0000, v34
  v_add_f32 v14, v14, v44
  v_add_f32 v15, v15, v45
  v_lshlrev_b32 v46, 16, v35
  v_and_b32 v47, 0xffff0000, v35
  v_add_f32 v14, v14, v46
  v_add_f32 v15, v15, v47
  v_lshlrev_b32 v44, 16, v36
  v_and_b32 v45, 0xffff0000, v36
  v_add_f32 v16, v16, v44
  v_add_f32 v17, v17, v45
  v_lshlrev_b32 v46, 16, v37
  v_and_b32 v47, 0xffff0000, v37
  v_add_f32 v16, v16, v46
  v_add_f32 v17, v17, v47
  v_lshlrev_b32 v44, 16, v38
  v_and_b32 v45, 0xffff0000, v38
  v_add_f32 v16, v16, v44
  v_add_f32 v17, v17, v45
  v_lshlrev_b32 v46, 16, v39
  v_and_b32 v47, 0xffff0000, v39
  v_add_f32 v16, v16, v46
  v_add_f32 v17, v17, v47
  v_lshlrev_b32 v44, 16, v40
  v_and_b32 v45, 0xffff0000, v40
  v_add_f32 v18, v18, v44
  v_add_f32 v19, v19, v45
  v_lshlrev_b32 v46, 16, v41
  v_and_b32 v47, 0xffff0000, v41
  v_add_f32 v18, v18, v46
  v_add_f32 v19, v19, v47
  v_lshlrev_b32 v44, 16, v42
  v_and_b32 v45, 0xffff0000, v42
  v_add_f32 v18, v18, v44
  v_add_f32 v19, v19, v45
  v_lshlrev_b32 v46, 16, v43
  v_and_b32 v47, 0xffff0000, v43
  v_add_f32 v18, v18, v46
  v_add_f32 v19, v19, v47
  s_waitcnt vmcnt(7)
  s_barrier
  ds_read_b64_tr_b16 v[20:21], v10 offset:0
  ds_read_b64_tr_b16 v[22:23], v10 offset:768
  ds_read_b64_tr_b16 v[24:25], v10 offset:64
  ds_read_b64_tr_b16 v[26:27], v10 offset:832
  ds_read_b64_tr_b16 v[28:29], v10 offset:128
  ds_read_b64_tr_b16 v[30:31], v10 offset:896
  s_mov_b32 s57, 28672
  v_add_u32 v10, s57, v10
  s_waitcnt lgkmcnt(0)
  v_lshlrev_b32 v44, 16, v20
  v_and_b32 v45, 0xffff0000, v20
  v_add_f32 v14, v14, v44
  v_add_f32 v15, v15, v45
  v_lshlrev_b32 v46, 16, v21
  v_and_b32 v47, 0xffff0000, v21
  v_add_f32 v14, v14, v46
  v_add_f32 v15, v15, v47
  v_lshlrev_b32 v44, 16, v22
  v_and_b32 v45, 0xffff0000, v22
  v_add_f32 v14, v14, v44
  v_add_f32 v15, v15, v45
  v_lshlrev_b32 v46, 16, v23
  v_and_b32 v47, 0xffff0000, v23
  v_add_f32 v14, v14, v46
  v_add_f32 v15, v15, v47
  v_lshlrev_b32 v44, 16, v24
  v_and_b32 v45, 0xffff0000, v24
  v_add_f32 v16, v16, v44
  v_add_f32 v17, v17, v45
  v_lshlrev_b32 v46, 16, v25
  v_and_b32 v47, 0xffff0000, v25
  v_add_f32 v16, v16, v46
  v_add_f32 v17, v17, v47
  v_lshlrev_b32 v44, 16, v26
  v_and_b32 v45, 0xffff0000, v26
  v_add_f32 v16, v16, v44
  v_add_f32 v17, v17, v45
  v_lshlrev_b32 v46, 16, v27
  v_and_b32 v47, 0xffff0000, v27
  v_add_f32 v16, v16, v46
  v_add_f32 v17, v17, v47
  v_lshlrev_b32 v44, 16, v28
  v_and_b32 v45, 0xffff0000, v28
  v_add_f32 v18, v18, v44
  v_add_f32 v19, v19, v45
  v_lshlrev_b32 v46, 16, v29
  v_and_b32 v47, 0xffff0000, v29
  v_add_f32 v18, v18, v46
  v_add_f32 v19, v19, v47
  v_lshlrev_b32 v44, 16, v30
  v_and_b32 v45, 0xffff0000, v30
  v_add_f32 v18, v18, v44
  v_add_f32 v19, v19, v45
  v_lshlrev_b32 v46, 16, v31
  v_and_b32 v47, 0xffff0000, v31
  v_add_f32 v18, v18, v46
  v_add_f32 v19, v19, v47
  s_waitcnt vmcnt(0)
  s_barrier
  ds_read_b64_tr_b16 v[32:33], v10 offset:0
  ds_read_b64_tr_b16 v[34:35], v10 offset:768
  ds_read_b64_tr_b16 v[36:37], v10 offset:64
  ds_read_b64_tr_b16 v[38:39], v10 offset:832
  ds_read_b64_tr_b16 v[40:41], v10 offset:128
  ds_read_b64_tr_b16 v[42:43], v10 offset:896
  s_mov_b32 s57, 28672
  v_add_u32 v10, s57, v10
  s_waitcnt lgkmcnt(0)
  v_lshlrev_b32 v44, 16, v32
  v_and_b32 v45, 0xffff0000, v32
  v_add_f32 v14, v14, v44
  v_add_f32 v15, v15, v45
  v_lshlrev_b32 v46, 16, v33
  v_and_b32 v47, 0xffff0000, v33
  v_add_f32 v14, v14, v46
  v_add_f32 v15, v15, v47
  v_lshlrev_b32 v44, 16, v34
  v_and_b32 v45, 0xffff0000, v34
  v_add_f32 v14, v14, v44
  v_add_f32 v15, v15, v45
  v_lshlrev_b32 v46, 16, v35
  v_and_b32 v47, 0xffff0000, v35
  v_add_f32 v14, v14, v46
  v_add_f32 v15, v15, v47
  v_lshlrev_b32 v44, 16, v36
  v_and_b32 v45, 0xffff0000, v36
  v_add_f32 v16, v16, v44
  v_add_f32 v17, v17, v45
  v_lshlrev_b32 v46, 16, v37
  v_and_b32 v47, 0xffff0000, v37
  v_add_f32 v16, v16, v46
  v_add_f32 v17, v17, v47
  v_lshlrev_b32 v44, 16, v38
  v_and_b32 v45, 0xffff0000, v38
  v_add_f32 v16, v16, v44
  v_add_f32 v17, v17, v45
  v_lshlrev_b32 v46, 16, v39
  v_and_b32 v47, 0xffff0000, v39
  v_add_f32 v16, v16, v46
  v_add_f32 v17, v17, v47
  v_lshlrev_b32 v44, 16, v40
  v_and_b32 v45, 0xffff0000, v40
  v_add_f32 v18, v18, v44
  v_add_f32 v19, v19, v45
  v_lshlrev_b32 v46, 16, v41
  v_and_b32 v47, 0xffff0000, v41
  v_add_f32 v18, v18, v46
  v_add_f32 v19, v19, v47
  v_lshlrev_b32 v44, 16, v42
  v_and_b32 v45, 0xffff0000, v42
  v_add_f32 v18, v18, v44
  v_add_f32 v19, v19, v45
  v_lshlrev_b32 v46, 16, v43
  v_and_b32 v47, 0xffff0000, v43
  v_add_f32 v18, v18, v46
  v_add_f32 v19, v19, v47
  s_nop 2
  v_and_b32 v11, 31, v0
  v_lshlrev_b32 v11, 2, v11
  v_add_u32 v11, 143360, v11
  v_add_f32 v14, v14, v15
  v_mov_b32 v15, v14
  v_add_f32 v16, v16, v17
  v_mov_b32 v17, v16
  v_add_f32 v18, v18, v19
  v_mov_b32 v19, v18
  s_nop 1
  v_permlane32_swap_b32 v14, v15
  v_permlane32_swap_b32 v16, v17
  v_permlane32_swap_b32 v18, v19
  s_nop 1
  v_add_f32 v14, v14, v15
  v_add_f32 v16, v16, v17
  v_add_f32 v18, v18, v19
  s_mul_i32 s56, s48, 384
  s_add_u32 s56, s56, 1536
  v_add_u32 v12, s56, v11
  ds_write_b32 v12, v14 offset:0
  ds_write_b32 v12, v16 offset:128
  ds_write_b32 v12, v18 offset:256
  s_waitcnt lgkmcnt(0)
  s_barrier
  s_cmp_eq_u32 s48, 3
  s_cbranch_scc1 sequential_preLN__mha_block__dense_activation_squared_relu__prompt_kernel_cf_35
  s_lshl_b32 s56, s48, 7
  v_add_u32 v12, s56, v11
  ds_read_b32 v20, v12 offset:1536
  ds_read_b32 v21, v12 offset:1920
  ds_read_b32 v22, v12 offset:2304
  ds_read_b32 v23, v12 offset:2688
  s_waitcnt lgkmcnt(0)
  v_add_f32 v20, v20, v21
  v_add_f32 v22, v22, v23
  v_add_f32 v20, v20, v22
  ds_write_b32 v12, v20
  s_waitcnt lgkmcnt(0)
sequential_preLN__mha_block__dense_activation_squared_relu__prompt_kernel_cf_35:
  s_barrier
sequential_preLN__mha_block__dense_activation_squared_relu__prompt_kernel_A_join:
  s_barrier
  s_cmp_lg_u32 s3, 0
  s_cbranch_scc1 sequential_preLN__mha_block__dense_activation_squared_relu__prompt_kernel_nw0_36
  s_lshl_b32 s50, s47, 4
  s_add_u32 s50, s50, s46
  s_lshl_b32 s50, s50, 7
  s_add_u32 s50, s50, 23068672
  v_mov_b32 v2, 0
  v_mov_b32 v3, s4
  s_mov_b64 exec, 1
  buffer_store_dword v3, v2, s[8:11], s50 offen sc1
  s_mov_b64 exec, -1
sequential_preLN__mha_block__dense_activation_squared_relu__prompt_kernel_nw0_36:
  v_mov_b32 v2, 149504
  ds_read_b32 v3, v2
  s_waitcnt lgkmcnt(0)
  v_readfirstlane_b32 s4, v3
  s_nop 3
  s_and_b32 s50, s2, 7
  s_lshr_b32 s51, s2, 3
  s_and_b32 s51, s51, 3
  s_lshl_b32 s46, s50, 2
  s_add_u32 s46, s46, s51
  s_lshr_b32 s47, s2, 5
  s_and_b32 s48, s3, 3
  s_lshr_b32 s49, s3, 2
  v_lshlrev_b32 v1, 4, v0
  s_lshl_b32 s50, s46, 16
  s_and_b32 s51, s3, 1
  s_lshl_b32 s51, s51, 10
  s_bfe_u32 s52, s3, 0x10001
  s_lshl_b32 s52, s52, 15
  s_add_u32 s51, s51, s52
  s_cmp_ge_u32 s3, 4
  s_mov_b32 s52, 2097152
  s_cselect_b32 s52, 4194304, s52
  s_cselect_b32 s53, 65536, 0
  s_add_u32 s50, s50, s52
  s_add_u32 s50, s50, s51
  s_add_u32 s53, s53, s51
  s_lshl_b32 s54, s47, 3
  s_lshl_b32 s55, s48, 1
  s_add_u32 s54, s54, s55
  s_lshl_b32 s55, s46, 6
  s_add_u32 s55, s55, s54
  s_lshl_b32 s55, s55, 10
  s_add_u32 s55, s55, 0
  s_lshl_b32 s57, s49, 15
  v_add_u32 v108, s57, v1
  v_lshrrev_b32 v2, 5, v0
  v_and_b32 v3, 15, v0
  v_lshlrev_b32 v3, 4, v3
  v_lshl_add_u32 v3, v2, 8, v3
  s_add_u32 s57, s57, 65536
  v_add_u32 v109, s57, v3
  v_and_b32 v3, 27, v0
  v_cmp_eq_u32 vcc, 16, v3
  v_mov_b32 v110, 0x3f803f80
  s_nop 1
  v_cndmask_b32 v110, 0, v110, vcc
  v_mov_b32 v20, v110
  v_mov_b32 v21, v110
  v_mov_b32 v22, v110
  v_mov_b32 v23, v110
  v_mov_b32 v24, v110
  v_mov_b32 v25, v110
  v_mov_b32 v26, v110
  v_mov_b32 v27, v110
  v_mov_b32 v28, v110
  v_mov_b32 v29, v110
  v_mov_b32 v30, v110
  v_mov_b32 v31, v110
  v_mov_b32 v32, v110
  v_mov_b32 v33, v110
  v_mov_b32 v34, v110
  v_mov_b32 v35, v110
  v_mov_b32 v76, 0
  v_mov_b32 v77, 0
  v_mov_b32 v78, 0
  v_mov_b32 v79, 0
  v_mov_b32 v80, 0
  v_mov_b32 v81, 0
  v_mov_b32 v82, 0
  v_mov_b32 v83, 0
  v_mov_b32 v84, 0
  v_mov_b32 v85, 0
  v_mov_b32 v86, 0
  v_mov_b32 v87, 0
  v_mov_b32 v88, 0
  v_mov_b32 v89, 0
  v_mov_b32 v90, 0
  v_mov_b32 v91, 0
  v_mov_b32 v92, 0
  v_mov_b32 v93, 0
  v_mov_b32 v94, 0
  v_mov_b32 v95, 0
  v_mov_b32 v96, 0
  v_mov_b32 v97, 0
  v_mov_b32 v98, 0
  v_mov_b32 v99, 0
  v_mov_b32 v100, 0
  v_mov_b32 v101, 0
  v_mov_b32 v102, 0
  v_mov_b32 v103, 0
  v_mov_b32 v104, 0
  v_mov_b32 v105, 0
  v_mov_b32 v106, 0
  v_mov_b32 v107, 0
  s_cmp_lg_u32 s3, 0
  s_cbranch_scc1 sequential_preLN__mha_block__dense_activation_squared_relu__prompt_kernel_nw0_37
  s_lshr_b32 s56, s46, 1
  s_add_u32 s57, s56, 16
  s_mul_hi_u32 s57, s57, 0x55555556
  s_add_u32 s58, s56, 32
  s_mul_hi_u32 s58, s58, 0x55555556
  s_mul_hi_u32 s56, s56, 0x55555556
  s_lshl_b32 s57, s57, 4
  s_lshl_b32 s58, s58, 4
  s_lshl_b32 s56, s56, 4
  s_lshl_b32 s62, s47, 1
  s_add_u32 s56, s56, s62
  s_sub_u32 s56, s56, 32
  s_sub_u32 s58, s58, 16
  v_mov_b32 v2, s57
  v_mov_b32 v3, s58
  v_cmp_lt_u32 vcc, 15, v0
  s_nop 1
  v_cndmask_b32 v2, v2, v3, vcc
  v_mov_b32 v3, s56
  v_cmp_lt_u32 vcc, 31, v0
  s_nop 1
  v_cndmask_b32 v2, v2, v3, vcc
  v_add_u32 v2, v2, v0
  v_lshlrev_b32 v2, 7, v2
  s_mov_b32 s56, 23068672
  s_mov_b32 exec_lo, 0xffffffff
  s_mov_b32 exec_hi, 0x3
  s_mov_b32 s58, 0
sequential_preLN__mha_block__dense_activation_squared_relu__prompt_kernel_poll_38:
  buffer_load_dword v140, v2, s[8:11], s56 offen sc1
sequential_preLN__mha_block__dense_activation_squared_relu__prompt_kernel_pchk_40:
  s_add_u32 s58, s58, 1
  s_waitcnt vmcnt(0)
  v_cmp_eq_u32 vcc, s4, v140
  s_cmp_gt_u32 s58, 200000
  s_cbranch_scc1 sequential_preLN__mha_block__dense_activation_squared_relu__prompt_kernel_pdone_39
  s_cmp_eq_u64 vcc, exec
  s_cbranch_scc0 sequential_preLN__mha_block__dense_activation_squared_relu__prompt_kernel_poll_38
sequential_preLN__mha_block__dense_activation_squared_relu__prompt_kernel_pdone_39:
  s_mov_b64 exec, -1
sequential_preLN__mha_block__dense_activation_squared_relu__prompt_kernel_nw0_37:
  s_barrier
  buffer_load_dwordx4 v[4:7], v1, s[8:11], s55 offen sc1
  buffer_load_dwordx4 v[8:11], v1, s[8:11], s55 offen offset:1024 sc1
  s_add_u32 m0, s53, 0
  s_add_u32 s56, s50, 0
  buffer_load_dwordx4 v1, s[8:11], s56 offen sc1 lds
  s_barrier
  s_add_u32 m0, s53, 2048
  s_add_u32 s56, s50, 2048
  buffer_load_dwordx4 v1, s[8:11], s56 offen sc1 lds
  s_barrier
  s_add_u32 m0, s53, 4096
  s_add_u32 s56, s50, 4096
  buffer_load_dwordx4 v1, s[8:11], s56 offen sc1 lds
  s_add_u32 m0, s53, 6144
  s_add_u32 s56, s50, 6144
  buffer_load_dwordx4 v1, s[8:11], s56 offen sc1 lds
  s_mov_b32 s60, 0x0000ffff
  s_mov_b32 s61, 0x0000ffff
  s_waitcnt vmcnt(3)
  s_barrier
  s_cmp_lt_u32 s3, 4
  s_cbranch_scc1 sequential_preLN__mha_block__dense_activation_squared_relu__prompt_kernel_noprio_41
  s_setprio 1
sequential_preLN__mha_block__dense_activation_squared_relu__prompt_kernel_noprio_41:
  ds_read_b128 v[12:15], v108 offset:0
  s_mov_b64 exec, s[60:61]
  ds_read_b128 v[20:23], v109 offset:0
  ds_read_b128 v[24:27], v109 offset:512
  s_mov_b64 exec, -1
  s_waitcnt lgkmcnt(0)
  v_mfma_f32_32x32x16_bf16 v[36:51], v[12:15], v[4:7], 0
  s_add_u32 m0, s53, 8192
  s_add_u32 s56, s50, 8192
  buffer_load_dwordx4 v1, s[8:11], s56 offen sc1 lds
  s_add_u32 m0, s53, 10240
  s_add_u32 s56, s50, 10240
  buffer_load_dwordx4 v1, s[8:11], s56 offen sc1 lds
  s_nop 7
  v_exp_f32 v36, v36
  v_exp_f32 v37, v37
  v_exp_f32 v38, v38
  v_exp_f32 v39, v39
  v_cvt_pk_bf16_f32 v68, v36, v37
  v_exp_f32 v40, v40
  v_exp_f32 v41, v41
  v_cvt_pk_bf16_f32 v69, v38, v39
  v_mfma_f32_32x32x16_bf16 v[52:67], v[12:15], v[8:11], 0
  ds_read_b128 v[16:19], v108 offset:1024
  s_mov_b64 exec, s[60:61]
  ds_read_b128 v[28:31], v109 offset:1024
  ds_read_b128 v[32:35], v109 offset:1536
  s_mov_b64 exec, -1
  v_exp_f32 v42, v42
  v_exp_f32 v43, v43
  v_cvt_pk_bf16_f32 v70, v40, v41
  v_exp_f32 v44, v44
  v_cvt_pk_bf16_f32 v71, v42, v43
  v_exp_f32 v45, v45
  v_exp_f32 v46, v46
  v_mfma_f32_32x32x16_bf16 v[76:91], v[20:23], v[68:71], v[76:91]
  s_add_u32 m0, s53, 12288
  s_add_u32 s56, s50, 12288
  buffer_load_dwordx4 v1, s[8:11], s56 offen sc1 lds
  s_add_u32 m0, s53, 14336
  s_add_u32 s56, s50, 14336
  buffer_load_dwordx4 v1, s[8:11], s56 offen sc1 lds
  v_exp_f32 v47, v47
  v_cvt_pk_bf16_f32 v72, v44, v45
  v_exp_f32 v48, v48
  v_exp_f32 v49, v49
  v_cvt_pk_bf16_f32 v73, v46, v47
  v_exp_f32 v50, v50
  v_exp_f32 v51, v51
  v_cvt_pk_bf16_f32 v74, v48, v49
  v_cvt_pk_bf16_f32 v75, v50, v51
  v_exp_f32 v52, v52
  v_exp_f32 v53, v53
  v_mfma_f32_32x32x16_bf16 v[76:91], v[24:27], v[72:75], v[76:91]
  v_exp_f32 v54, v54
  v_exp_f32 v55, v55
  v_cvt_pk_bf16_f32 v68, v52, v53
  v_exp_f32 v56, v56
  v_exp_f32 v57, v57
  v_cvt_pk_bf16_f32 v69, v54, v55
  s_waitcnt lgkmcnt(0)
  v_mfma_f32_32x32x16_bf16 v[36:51], v[16:19], v[4:7], 0
  v_exp_f32 v58, v58
  v_exp_f32 v59, v59
  v_cvt_pk_bf16_f32 v70, v56, v57
  v_exp_f32 v60, v60
  v_cvt_pk_bf16_f32 v71, v58, v59
  v_exp_f32 v61, v61
  v_exp_f32 v62, v62
  v_mfma_f32_32x32x16_bf16 v[92:107], v[20:23], v[68:71], v[92:107]
  v_exp_f32 v63, v63
  v_cvt_pk_bf16_f32 v72, v60, v61
  v_exp_f32 v64, v64
  v_exp_f32 v65, v65
  v_cvt_pk_bf16_f32 v73, v62, v63
  v_exp_f32 v66, v66
  v_exp_f32 v67, v67
  v_cvt_pk_bf16_f32 v74, v64, v65
  v_cvt_pk_bf16_f32 v75, v66, v67
  s_waitcnt vmcnt(4)
  s_barrier
  v_exp_f32 v36, v36
  v_exp_f32 v37, v37
  v_mfma_f32_32x32x16_bf16 v[92:107], v[24:27], v[72:75], v[92:107]
  v_exp_f32 v38, v38
  v_exp_f32 v39, v39
  v_cvt_pk_bf16_f32 v68, v36, v37
  v_exp_f32 v40, v40
  v_exp_f32 v41, v41
  v_cvt_pk_bf16_f32 v69, v38, v39
  v_mfma_f32_32x32x16_bf16 v[52:67], v[16:19], v[8:11], 0
  ds_read_b128 v[12:15], v108 offset:2048
  s_mov_b64 exec, s[60:61]
  ds_read_b128 v[20:23], v109 offset:2048
  ds_read_b128 v[24:27], v109 offset:2560
  s_mov_b64 exec, -1
  v_exp_f32 v42, v42
  v_exp_f32 v43, v43
  v_cvt_pk_bf16_f32 v70, v40, v41
  v_exp_f32 v44, v44
  v_cvt_pk_bf16_f32 v71, v42, v43
  v_exp_f32 v45, v45
  v_exp_f32 v46, v46
  v_mfma_f32_32x32x16_bf16 v[76:91], v[28:31], v[68:71], v[76:91]
  s_add_u32 m0, s53, 16384
  s_add_u32 s56, s50, 16384
  buffer_load_dwordx4 v1, s[8:11], s56 offen sc1 lds
  s_add_u32 m0, s53, 18432
  s_add_u32 s56, s50, 18432
  buffer_load_dwordx4 v1, s[8:11], s56 offen sc1 lds
  v_exp_f32 v47, v47
  v_cvt_pk_bf16_f32 v72, v44, v45
  v_exp_f32 v48, v48
  v_exp_f32 v49, v49
  v_cvt_pk_bf16_f32 v73, v46, v47
  v_exp_f32 v50, v50
  v_exp_f32 v51, v51
  v_cvt_pk_bf16_f32 v74, v48, v49
  v_cvt_pk_bf16_f32 v75, v50, v51
  v_exp_f32 v52, v52
  v_exp_f32 v53, v53
  v_mfma_f32_32x32x16_bf16 v[76:91], v[32:35], v[72:75], v[76:91]
  v_exp_f32 v54, v54
  v_exp_f32 v55, v55
  v_cvt_pk_bf16_f32 v68, v52, v53
  v_exp_f32 v56, v56
  v_exp_f32 v57, v57
  v_cvt_pk_bf16_f32 v69, v54, v55
  s_waitcnt lgkmcnt(0)
  v_mfma_f32_32x32x16_bf16 v[36:51], v[12:15], v[4:7], 0
  v_exp_f32 v58, v58
  v_exp_f32 v59, v59
  v_cvt_pk_bf16_f32 v70, v56, v57
  v_exp_f32 v60, v60
  v_cvt_pk_bf16_f32 v71, v58, v59
  v_exp_f32 v61, v61
  v_exp_f32 v62, v62
  v_mfma_f32_32x32x16_bf16 v[92:107], v[28:31], v[68:71], v[92:107]
  s_add_u32 m0, s53, 20480
  s_add_u32 s56, s50, 20480
  buffer_load_dwordx4 v1, s[8:11], s56 offen sc1 lds
  s_add_u32 m0, s53, 22528
  s_add_u32 s56, s50, 22528
  buffer_load_dwordx4 v1, s[8:11], s56 offen sc1 lds
  v_exp_f32 v63, v63
  v_cvt_pk_bf16_f32 v72, v60, v61
  v_exp_f32 v64, v64
  v_exp_f32 v65, v65
  v_cvt_pk_bf16_f32 v73, v62, v63
  v_exp_f32 v66, v66
  v_exp_f32 v67, v67
  v_cvt_pk_bf16_f32 v74, v64, v65
  v_cvt_pk_bf16_f32 v75, v66, v67
  v_exp_f32 v36, v36
  v_exp_f32 v37, v37
  v_mfma_f32_32x32x16_bf16 v[92:107], v[32:35], v[72:75], v[92:107]
  v_exp_f32 v38, v38
  v_exp_f32 v39, v39
  v_cvt_pk_bf16_f32 v68, v36, v37
  v_exp_f32 v40, v40
  v_exp_f32 v41, v41
  v_cvt_pk_bf16_f32 v69, v38, v39
  v_mfma_f32_32x32x16_bf16 v[52:67], v[12:15], v[8:11], 0
  ds_read_b128 v[16:19], v108 offset:3072
  s_mov_b64 exec, s[60:61]
  ds_read_b128 v[28:31], v109 offset:3072
  ds_read_b128 v[32:35], v109 offset:3584
  s_mov_b64 exec, -1
  v_exp_f32 v42, v42
  v_exp_f32 v43, v43
  v_cvt_pk_bf16_f32 v70, v40, v41
  v_exp_f32 v44, v44
  v_cvt_pk_bf16_f32 v71, v42, v43
  v_exp_f32 v45, v45
  v_exp_f32 v46, v46
  v_mfma_f32_32x32x16_bf16 v[76:91], v[20:23], v[68:71], v[76:91]
  s_add_u32 m0, s53, 24576
  s_add_u32 s56, s50, 24576
  buffer_load_dwordx4 v1, s[8:11], s56 offen sc1 lds
  s_add_u32 m0, s53, 26624
  s_add_u32 s56, s50, 26624
  buffer_load_dwordx4 v1, s[8:11], s56 offen sc1 lds
  v_exp_f32 v47, v47
  v_cvt_pk_bf16_f32 v72, v44, v45
  v_exp_f32 v48, v48
  v_exp_f32 v49, v49
  v_cvt_pk_bf16_f32 v73, v46, v47
  v_exp_f32 v50, v50
  v_exp_f32 v51, v51
  v_cvt_pk_bf16_f32 v74, v48, v49
  v_cvt_pk_bf16_f32 v75, v50, v51
  v_exp_f32 v52, v52
  v_exp_f32 v53, v53
  v_mfma_f32_32x32x16_bf16 v[76:91], v[24:27], v[72:75], v[76:91]
  v_exp_f32 v54, v54
  v_exp_f32 v55, v55
  v_cvt_pk_bf16_f32 v68, v52, v53
  v_exp_f32 v56, v56
  v_exp_f32 v57, v57
  v_cvt_pk_bf16_f32 v69, v54, v55
  s_waitcnt lgkmcnt(0)
  v_mfma_f32_32x32x16_bf16 v[36:51], v[16:19], v[4:7], 0
  v_exp_f32 v58, v58
  v_exp_f32 v59, v59
  v_cvt_pk_bf16_f32 v70, v56, v57
  v_exp_f32 v60, v60
  v_cvt_pk_bf16_f32 v71, v58, v59
  v_exp_f32 v61, v61
  v_exp_f32 v62, v62
  v_mfma_f32_32x32x16_bf16 v[92:107], v[20:23], v[68:71], v[92:107]
  s_add_u32 m0, s53, 28672
  s_add_u32 s56, s50, 28672
  buffer_load_dwordx4 v1, s[8:11], s56 offen sc1 lds
  s_add_u32 m0, s53, 30720
  s_add_u32 s56, s50, 30720
  buffer_load_dwordx4 v1, s[8:11], s56 offen sc1 lds
  v_exp_f32 v63, v63
  v_cvt_pk_bf16_f32 v72, v60, v61
  v_exp_f32 v64, v64
  v_exp_f32 v65, v65
  v_cvt_pk_bf16_f32 v73, v62, v63
  v_exp_f32 v66, v66
  v_exp_f32 v67, v67
  v_cvt_pk_bf16_f32 v74, v64, v65
  v_cvt_pk_bf16_f32 v75, v66, v67
  v_exp_f32 v36, v36
  v_exp_f32 v37, v37
  v_mfma_f32_32x32x16_bf16 v[92:107], v[24:27], v[72:75], v[92:107]
  v_exp_f32 v38, v38
  v_exp_f32 v39, v39
  v_cvt_pk_bf16_f32 v68, v36, v37
  v_exp_f32 v40, v40
  v_exp_f32 v41, v41
  v_cvt_pk_bf16_f32 v69, v38, v39
  v_mfma_f32_32x32x16_bf16 v[52:67], v[16:19], v[8:11], 0
  ds_read_b128 v[12:15], v108 offset:4096
  s_mov_b64 exec, s[60:61]
  ds_read_b128 v[20:23], v109 offset:4096
  ds_read_b128 v[24:27], v109 offset:4608
  s_mov_b64 exec, -1
  v_exp_f32 v42, v42
  v_exp_f32 v43, v43
  v_cvt_pk_bf16_f32 v70, v40, v41
  v_exp_f32 v44, v44
  v_cvt_pk_bf16_f32 v71, v42, v43
  v_exp_f32 v45, v45
  v_exp_f32 v46, v46
  v_mfma_f32_32x32x16_bf16 v[76:91], v[28:31], v[68:71], v[76:91]
  v_exp_f32 v47, v47
  v_cvt_pk_bf16_f32 v72, v44, v45
  v_exp_f32 v48, v48
  v_exp_f32 v49, v49
  v_cvt_pk_bf16_f32 v73, v46, v47
  v_exp_f32 v50, v50
  v_exp_f32 v51, v51
  v_cvt_pk_bf16_f32 v74, v48, v49
  v_cvt_pk_bf16_f32 v75, v50, v51
  v_exp_f32 v52, v52
  v_exp_f32 v53, v53
  v_mfma_f32_32x32x16_bf16 v[76:91], v[32:35], v[72:75], v[76:91]
  v_exp_f32 v54, v54
  v_exp_f32 v55, v55
  v_cvt_pk_bf16_f32 v68, v52, v53
  v_exp_f32 v56, v56
  v_exp_f32 v57, v57
  v_cvt_pk_bf16_f32 v69, v54, v55
  s_waitcnt lgkmcnt(0)
  v_mfma_f32_32x32x16_bf16 v[36:51], v[12:15], v[4:7], 0
  v_exp_f32 v58, v58
  v_exp_f32 v59, v59
  v_cvt_pk_bf16_f32 v70, v56, v57
  v_exp_f32 v60, v60
  v_cvt_pk_bf16_f32 v71, v58, v59
  v_exp_f32 v61, v61
  v_exp_f32 v62, v62
  v_mfma_f32_32x32x16_bf16 v[92:107], v[28:31], v[68:71], v[92:107]
  v_exp_f32 v63, v63
  v_cvt_pk_bf16_f32 v72, v60, v61
  v_exp_f32 v64, v64
  v_exp_f32 v65, v65
  v_cvt_pk_bf16_f32 v73, v62, v63
  v_exp_f32 v66, v66
  v_exp_f32 v67, v67
  v_cvt_pk_bf16_f32 v74, v64, v65
  v_cvt_pk_bf16_f32 v75, v66, v67
  s_waitcnt vmcnt(0)
  s_barrier
  v_exp_f32 v36, v36
  v_exp_f32 v37, v37
  v_mfma_f32_32x32x16_bf16 v[92:107], v[32:35], v[72:75], v[92:107]
  v_exp_f32 v38, v38
  v_exp_f32 v39, v39
  v_cvt_pk_bf16_f32 v68, v36, v37
  v_exp_f32 v40, v40
  v_exp_f32 v41, v41
  v_cvt_pk_bf16_f32 v69, v38, v39
  v_mfma_f32_32x32x16_bf16 v[52:67], v[12:15], v[8:11], 0
  ds_read_b128 v[16:19], v108 offset:5120
  s_mov_b64 exec, s[60:61]
  ds_read_b128 v[28:31], v109 offset:5120
  ds_read_b128 v[32:35], v109 offset:5632
  s_mov_b64 exec, -1
  v_exp_f32 v42, v42
  v_exp_f32 v43, v43
  v_cvt_pk_bf16_f32 v70, v40, v41
  v_exp_f32 v44, v44
  v_cvt_pk_bf16_f32 v71, v42, v43
  v_exp_f32 v45, v45
  v_exp_f32 v46, v46
  v_mfma_f32_32x32x16_bf16 v[76:91], v[20:23], v[68:71], v[76:91]
  s_cmp_lt_u32 s3, 4
  s_cbranch_scc1 sequential_preLN__mha_block__dense_activation_squared_relu__prompt_kernel_yg_42
  s_lshl_b32 s62, s2, 3
  s_and_b32 s56, s3, 3
  s_lshl_b32 s56, s56, 1
  s_add_u32 s62, s62, s56
  s_cmp_lt_u32 s62, 512
  s_cbranch_scc0 sequential_preLN__mha_block__dense_activation_squared_relu__prompt_kernel_rw1_43
  s_mov_b32 s16, s28
  s_and_b32 s17, s29, 0xffff
  s_mov_b32 s18, 524288
  s_mov_b32 s19, 0x20000
  s_lshr_b32 s56, s62, 5
  s_lshl_b32 s56, s56, 6
  s_and_b32 s57, s62, 31
  s_lshl_b32 s57, s57, 14
  s_add_u32 s56, s56, s57
  s_mov_b32 s63, 1024
  s_lshl_b32 s62, s62, 10
  s_add_u32 s62, s62, 17825792
  s_branch sequential_preLN__mha_block__dense_activation_squared_relu__prompt_kernel_rgo_45
sequential_preLN__mha_block__dense_activation_squared_relu__prompt_kernel_rw1_43:
  s_cmp_lt_u32 s62, 1888
  s_cbranch_scc0 sequential_preLN__mha_block__dense_activation_squared_relu__prompt_kernel_rw2_44
  s_mov_b32 s16, s32
  s_and_b32 s17, s33, 0xffff
  s_mov_b32 s18, 1409024
  s_mov_b32 s19, 0x20000
  s_sub_u32 s62, s62, 512
  s_lshr_b32 s56, s62, 5
  s_lshl_b32 s56, s56, 6
  s_and_b32 s57, s62, 31
  s_mul_i32 s57, s57, 44032
  s_add_u32 s56, s56, s57
  s_mov_b32 s63, 2752
  s_lshl_b32 s62, s62, 10
  s_add_u32 s62, s62, 18874368
  s_branch sequential_preLN__mha_block__dense_activation_squared_relu__prompt_kernel_rgo_45
sequential_preLN__mha_block__dense_activation_squared_relu__prompt_kernel_rw2_44:
  s_mov_b32 s16, s36
  s_and_b32 s17, s37, 0xffff
  s_mov_b32 s18, 1409024
  s_mov_b32 s19, 0x20000
  s_sub_u32 s62, s62, 1888
  s_mul_hi_u32 s56, s62, 49941481
  s_mul_i32 s57, s56, 86
  s_sub_u32 s57, s62, s57
  s_lshl_b32 s56, s56, 6
  s_lshl_b32 s57, s57, 14
  s_add_u32 s56, s56, s57
  s_mov_b32 s63, 1024
  s_lshl_b32 s62, s62, 10
  s_add_u32 s62, s62, 20971520
sequential_preLN__mha_block__dense_activation_squared_relu__prompt_kernel_rgo_45:
  s_mov_b32 s98, s62
  v_lshrrev_b32 v2, 2, v0
  v_mul_u32_u24 v2, s63, v2
  v_and_b32 v3, 3, v0
  v_lshl_add_u32 v2, v3, 4, v2
  s_and_b32 s57, s3, 3
  s_lshl_b32 s57, s57, 12
  s_add_u32 m0, s57, 131072
  s_nop 0
  buffer_load_dwordx4 v2, s[16:19], s56 offen lds
sequential_preLN__mha_block__dense_activation_squared_relu__prompt_kernel_yg_42:
  v_exp_f32 v47, v47
  v_cvt_pk_bf16_f32 v72, v44, v45
  v_exp_f32 v48, v48
  v_exp_f32 v49, v49
  v_cvt_pk_bf16_f32 v73, v46, v47
  v_exp_f32 v50, v50
  v_exp_f32 v51, v51
  v_cvt_pk_bf16_f32 v74, v48, v49
  v_cvt_pk_bf16_f32 v75, v50, v51
  v_exp_f32 v52, v52
  v_exp_f32 v53, v53
  v_mfma_f32_32x32x16_bf16 v[76:91], v[24:27], v[72:75], v[76:91]
  v_exp_f32 v54, v54
  v_exp_f32 v55, v55
  v_cvt_pk_bf16_f32 v68, v52, v53
  v_exp_f32 v56, v56
  v_exp_f32 v57, v57
  v_cvt_pk_bf16_f32 v69, v54, v55
  s_waitcnt lgkmcnt(0)
  v_mfma_f32_32x32x16_bf16 v[36:51], v[16:19], v[4:7], 0
  v_exp_f32 v58, v58
  v_exp_f32 v59, v59
  v_cvt_pk_bf16_f32 v70, v56, v57
  v_exp_f32 v60, v60
  v_cvt_pk_bf16_f32 v71, v58, v59
  v_exp_f32 v61, v61
  v_exp_f32 v62, v62
  v_mfma_f32_32x32x16_bf16 v[92:107], v[20:23], v[68:71], v[92:107]
  s_cmp_lt_u32 s3, 4
  s_cbranch_scc1 sequential_preLN__mha_block__dense_activation_squared_relu__prompt_kernel_yg_46
  s_lshl_b32 s62, s2, 3
  s_and_b32 s56, s3, 3
  s_lshl_b32 s56, s56, 1
  s_add_u32 s62, s62, s56
  s_add_u32 s62, s62, 2048
  s_cmp_lt_u32 s62, 512
  s_cbranch_scc0 sequential_preLN__mha_block__dense_activation_squared_relu__prompt_kernel_rw1_47
  s_mov_b32 s16, s28
  s_and_b32 s17, s29, 0xffff
  s_mov_b32 s18, 524288
  s_mov_b32 s19, 0x20000
  s_lshr_b32 s56, s62, 5
  s_lshl_b32 s56, s56, 6
  s_and_b32 s57, s62, 31
  s_lshl_b32 s57, s57, 14
  s_add_u32 s56, s56, s57
  s_mov_b32 s63, 1024
  s_lshl_b32 s62, s62, 10
  s_add_u32 s62, s62, 17825792
  s_branch sequential_preLN__mha_block__dense_activation_squared_relu__prompt_kernel_rgo_49
sequential_preLN__mha_block__dense_activation_squared_relu__prompt_kernel_rw1_47:
  s_cmp_lt_u32 s62, 1888
  s_cbranch_scc0 sequential_preLN__mha_block__dense_activation_squared_relu__prompt_kernel_rw2_48
  s_mov_b32 s16, s32
  s_and_b32 s17, s33, 0xffff
  s_mov_b32 s18, 1409024
  s_mov_b32 s19, 0x20000
  s_sub_u32 s62, s62, 512
  s_lshr_b32 s56, s62, 5
  s_lshl_b32 s56, s56, 6
  s_and_b32 s57, s62, 31
  s_mul_i32 s57, s57, 44032
  s_add_u32 s56, s56, s57
  s_mov_b32 s63, 2752
  s_lshl_b32 s62, s62, 10
  s_add_u32 s62, s62, 18874368
  s_branch sequential_preLN__mha_block__dense_activation_squared_relu__prompt_kernel_rgo_49
sequential_preLN__mha_block__dense_activation_squared_relu__prompt_kernel_rw2_48:
  s_mov_b32 s16, s36
  s_and_b32 s17, s37, 0xffff
  s_mov_b32 s18, 1409024
  s_mov_b32 s19, 0x20000
  s_sub_u32 s62, s62, 1888
  s_mul_hi_u32 s56, s62, 49941481
  s_mul_i32 s57, s56, 86
  s_sub_u32 s57, s62, s57
  s_lshl_b32 s56, s56, 6
  s_lshl_b32 s57, s57, 14
  s_add_u32 s56, s56, s57
  s_mov_b32 s63, 1024
  s_lshl_b32 s62, s62, 10
  s_add_u32 s62, s62, 20971520
sequential_preLN__mha_block__dense_activation_squared_relu__prompt_kernel_rgo_49:
  s_mov_b32 s99, s62
  v_lshrrev_b32 v2, 2, v0
  v_mul_u32_u24 v2, s63, v2
  v_and_b32 v3, 3, v0
  v_lshl_add_u32 v2, v3, 4, v2
  s_and_b32 s57, s3, 3
  s_lshl_b32 s57, s57, 12
  s_add_u32 m0, s57, 132096
  s_nop 0
  buffer_load_dwordx4 v2, s[16:19], s56 offen lds
sequential_preLN__mha_block__dense_activation_squared_relu__prompt_kernel_yg_46:
  v_exp_f32 v63, v63
  v_cvt_pk_bf16_f32 v72, v60, v61
  v_exp_f32 v64, v64
  v_exp_f32 v65, v65
  v_cvt_pk_bf16_f32 v73, v62, v63
  v_exp_f32 v66, v66
  v_exp_f32 v67, v67
  v_cvt_pk_bf16_f32 v74, v64, v65
  v_cvt_pk_bf16_f32 v75, v66, v67
  v_exp_f32 v36, v36
  v_exp_f32 v37, v37
  v_mfma_f32_32x32x16_bf16 v[92:107], v[24:27], v[72:75], v[92:107]
  v_exp_f32 v38, v38
  v_exp_f32 v39, v39
  v_cvt_pk_bf16_f32 v68, v36, v37
  v_exp_f32 v40, v40
  v_exp_f32 v41, v41
  v_cvt_pk_bf16_f32 v69, v38, v39
  v_mfma_f32_32x32x16_bf16 v[52:67], v[16:19], v[8:11], 0
  ds_read_b128 v[12:15], v108 offset:6144
  s_mov_b64 exec, s[60:61]
  ds_read_b128 v[20:23], v109 offset:6144
  ds_read_b128 v[24:27], v109 offset:6656
  s_mov_b64 exec, -1
  v_exp_f32 v42, v42
  v_exp_f32 v43, v43
  v_cvt_pk_bf16_f32 v70, v40, v41
  v_exp_f32 v44, v44
  v_cvt_pk_bf16_f32 v71, v42, v43
  v_exp_f32 v45, v45
  v_exp_f32 v46, v46
  v_mfma_f32_32x32x16_bf16 v[76:91], v[28:31], v[68:71], v[76:91]
  s_cmp_lt_u32 s3, 4
  s_cbranch_scc1 sequential_preLN__mha_block__dense_activation_squared_relu__prompt_kernel_yg_50
  s_lshl_b32 s62, s2, 3
  s_and_b32 s56, s3, 3
  s_lshl_b32 s56, s56, 1
  s_add_u32 s62, s62, s56
  s_add_u32 s62, s62, 1
  s_cmp_lt_u32 s62, 512
  s_cbranch_scc0 sequential_preLN__mha_block__dense_activation_squared_relu__prompt_kernel_rw1_51
  s_mov_b32 s16, s28
  s_and_b32 s17, s29, 0xffff
  s_mov_b32 s18, 524288
  s_mov_b32 s19, 0x20000
  s_lshr_b32 s56, s62, 5
  s_lshl_b32 s56, s56, 6
  s_and_b32 s57, s62, 31
  s_lshl_b32 s57, s57, 14
  s_add_u32 s56, s56, s57
  s_mov_b32 s63, 1024
  s_lshl_b32 s62, s62, 10
  s_add_u32 s62, s62, 17825792
  s_branch sequential_preLN__mha_block__dense_activation_squared_relu__prompt_kernel_rgo_53
sequential_preLN__mha_block__dense_activation_squared_relu__prompt_kernel_rw1_51:
  s_cmp_lt_u32 s62, 1888
  s_cbranch_scc0 sequential_preLN__mha_block__dense_activation_squared_relu__prompt_kernel_rw2_52
  s_mov_b32 s16, s32
  s_and_b32 s17, s33, 0xffff
  s_mov_b32 s18, 1409024
  s_mov_b32 s19, 0x20000
  s_sub_u32 s62, s62, 512
  s_lshr_b32 s56, s62, 5
  s_lshl_b32 s56, s56, 6
  s_and_b32 s57, s62, 31
  s_mul_i32 s57, s57, 44032
  s_add_u32 s56, s56, s57
  s_mov_b32 s63, 2752
  s_lshl_b32 s62, s62, 10
  s_add_u32 s62, s62, 18874368
  s_branch sequential_preLN__mha_block__dense_activation_squared_relu__prompt_kernel_rgo_53
sequential_preLN__mha_block__dense_activation_squared_relu__prompt_kernel_rw2_52:
  s_mov_b32 s16, s36
  s_and_b32 s17, s37, 0xffff
  s_mov_b32 s18, 1409024
  s_mov_b32 s19, 0x20000
  s_sub_u32 s62, s62, 1888
  s_mul_hi_u32 s56, s62, 49941481
  s_mul_i32 s57, s56, 86
  s_sub_u32 s57, s62, s57
  s_lshl_b32 s56, s56, 6
  s_lshl_b32 s57, s57, 14
  s_add_u32 s56, s56, s57
  s_mov_b32 s63, 1024
  s_lshl_b32 s62, s62, 10
  s_add_u32 s62, s62, 20971520
sequential_preLN__mha_block__dense_activation_squared_relu__prompt_kernel_rgo_53:
  s_mov_b32 s100, s62
  v_lshrrev_b32 v2, 2, v0
  v_mul_u32_u24 v2, s63, v2
  v_and_b32 v3, 3, v0
  v_lshl_add_u32 v2, v3, 4, v2
  s_and_b32 s57, s3, 3
  s_lshl_b32 s57, s57, 12
  s_add_u32 m0, s57, 133120
  s_nop 0
  buffer_load_dwordx4 v2, s[16:19], s56 offen lds
sequential_preLN__mha_block__dense_activation_squared_relu__prompt_kernel_yg_50:
  v_exp_f32 v47, v47
  v_cvt_pk_bf16_f32 v72, v44, v45
  v_exp_f32 v48, v48
  v_exp_f32 v49, v49
  v_cvt_pk_bf16_f32 v73, v46, v47
  v_exp_f32 v50, v50
  v_exp_f32 v51, v51
  v_cvt_pk_bf16_f32 v74, v48, v49
  v_cvt_pk_bf16_f32 v75, v50, v51
  v_exp_f32 v52, v52
  v_exp_f32 v53, v53
  v_mfma_f32_32x32x16_bf16 v[76:91], v[32:35], v[72:75], v[76:91]
  v_exp_f32 v54, v54
  v_exp_f32 v55, v55
  v_cvt_pk_bf16_f32 v68, v52, v53
  v_exp_f32 v56, v56
  v_exp_f32 v57, v57
  v_cvt_pk_bf16_f32 v69, v54, v55
  s_waitcnt lgkmcnt(0)
  v_mfma_f32_32x32x16_bf16 v[36:51], v[12:15], v[4:7], 0
  v_exp_f32 v58, v58
  v_exp_f32 v59, v59
  v_cvt_pk_bf16_f32 v70, v56, v57
  v_exp_f32 v60, v60
  v_cvt_pk_bf16_f32 v71, v58, v59
  v_exp_f32 v61, v61
  v_exp_f32 v62, v62
  v_mfma_f32_32x32x16_bf16 v[92:107], v[28:31], v[68:71], v[92:107]
  s_cmp_lt_u32 s3, 4
  s_cbranch_scc1 sequential_preLN__mha_block__dense_activation_squared_relu__prompt_kernel_yg_54
  s_lshl_b32 s62, s2, 3
  s_and_b32 s56, s3, 3
  s_lshl_b32 s56, s56, 1
  s_add_u32 s62, s62, s56
  s_add_u32 s62, s62, 1
  s_add_u32 s62, s62, 2048
  s_cmp_lt_u32 s62, 512
  s_cbranch_scc0 sequential_preLN__mha_block__dense_activation_squared_relu__prompt_kernel_rw1_55
  s_mov_b32 s16, s28
  s_and_b32 s17, s29, 0xffff
  s_mov_b32 s18, 524288
  s_mov_b32 s19, 0x20000
  s_lshr_b32 s56, s62, 5
  s_lshl_b32 s56, s56, 6
  s_and_b32 s57, s62, 31
  s_lshl_b32 s57, s57, 14
  s_add_u32 s56, s56, s57
  s_mov_b32 s63, 1024
  s_lshl_b32 s62, s62, 10
  s_add_u32 s62, s62, 17825792
  s_branch sequential_preLN__mha_block__dense_activation_squared_relu__prompt_kernel_rgo_57
sequential_preLN__mha_block__dense_activation_squared_relu__prompt_kernel_rw1_55:
  s_cmp_lt_u32 s62, 1888
  s_cbranch_scc0 sequential_preLN__mha_block__dense_activation_squared_relu__prompt_kernel_rw2_56
  s_mov_b32 s16, s32
  s_and_b32 s17, s33, 0xffff
  s_mov_b32 s18, 1409024
  s_mov_b32 s19, 0x20000
  s_sub_u32 s62, s62, 512
  s_lshr_b32 s56, s62, 5
  s_lshl_b32 s56, s56, 6
  s_and_b32 s57, s62, 31
  s_mul_i32 s57, s57, 44032
  s_add_u32 s56, s56, s57
  s_mov_b32 s63, 2752
  s_lshl_b32 s62, s62, 10
  s_add_u32 s62, s62, 18874368
  s_branch sequential_preLN__mha_block__dense_activation_squared_relu__prompt_kernel_rgo_57
sequential_preLN__mha_block__dense_activation_squared_relu__prompt_kernel_rw2_56:
  s_mov_b32 s16, s36
  s_and_b32 s17, s37, 0xffff
  s_mov_b32 s18, 1409024
  s_mov_b32 s19, 0x20000
  s_sub_u32 s62, s62, 1888
  s_mul_hi_u32 s56, s62, 49941481
  s_mul_i32 s57, s56, 86
  s_sub_u32 s57, s62, s57
  s_lshl_b32 s56, s56, 6
  s_lshl_b32 s57, s57, 14
  s_add_u32 s56, s56, s57
  s_mov_b32 s63, 1024
  s_lshl_b32 s62, s62, 10
  s_add_u32 s62, s62, 20971520
sequential_preLN__mha_block__dense_activation_squared_relu__prompt_kernel_rgo_57:
  s_mov_b32 s101, s62
  v_lshrrev_b32 v2, 2, v0
  v_mul_u32_u24 v2, s63, v2
  v_and_b32 v3, 3, v0
  v_lshl_add_u32 v2, v3, 4, v2
  s_and_b32 s57, s3, 3
  s_lshl_b32 s57, s57, 12
  s_add_u32 m0, s57, 134144
  s_nop 0
  buffer_load_dwordx4 v2, s[16:19], s56 offen lds
  s_lshl_b32 s62, s2, 3
  s_and_b32 s56, s3, 3
  s_lshl_b32 s56, s56, 1
  s_add_u32 s62, s62, s56
  s_mov_b32 s7, s62
  s_lshr_b32 s56, s62, 5
  s_lshl_b32 s56, s56, 15
  s_and_b32 s57, s62, 31
  s_lshl_b32 s57, s57, 5
  s_add_u32 s56, s56, s57
  v_and_b32 v2, 31, v0
  v_lshlrev_b32 v2, 10, v2
  v_lshrrev_b32 v3, 5, v0
  v_lshl_add_u32 v2, v3, 3, v2
  buffer_load_dwordx2 v[160:161], v2, s[12:15], s56 offen
  buffer_load_dwordx2 v[162:163], v2, s[12:15], s56 offen offset:16
  s_lshl_b32 s62, s2, 3
  s_and_b32 s56, s3, 3
  s_lshl_b32 s56, s56, 1
  s_add_u32 s62, s62, s56
  s_add_u32 s62, s62, 1
  s_lshr_b32 s56, s62, 5
  s_lshl_b32 s56, s56, 15
  s_and_b32 s57, s62, 31
  s_lshl_b32 s57, s57, 5
  s_add_u32 s56, s56, s57
  v_and_b32 v2, 31, v0
  v_lshlrev_b32 v2, 10, v2
  v_lshrrev_b32 v3, 5, v0
  v_lshl_add_u32 v2, v3, 3, v2
  buffer_load_dwordx2 v[164:165], v2, s[12:15], s56 offen
  buffer_load_dwordx2 v[166:167], v2, s[12:15], s56 offen offset:16
sequential_preLN__mha_block__dense_activation_squared_relu__prompt_kernel_yg_54:
  v_exp_f32 v63, v63
  v_cvt_pk_bf16_f32 v72, v60, v61
  v_exp_f32 v64, v64
  v_exp_f32 v65, v65
  v_cvt_pk_bf16_f32 v73, v62, v63
  v_exp_f32 v66, v66
  v_exp_f32 v67, v67
  v_cvt_pk_bf16_f32 v74, v64, v65
  v_cvt_pk_bf16_f32 v75, v66, v67
  v_exp_f32 v36, v36
  v_exp_f32 v37, v37
  v_mfma_f32_32x32x16_bf16 v[92:107], v[32:35], v[72:75], v[92:107]
  v_exp_f32 v38, v38
  v_exp_f32 v39, v39
  v_cvt_pk_bf16_f32 v68, v36, v37
  v_exp_f32 v40, v40
  v_exp_f32 v41, v41
  v_cvt_pk_bf16_f32 v69, v38, v39
  v_mfma_f32_32x32x16_bf16 v[52:67], v[12:15], v[8:11], 0
  ds_read_b128 v[16:19], v108 offset:7168
  s_mov_b64 exec, s[60:61]
  ds_read_b128 v[28:31], v109 offset:7168
  ds_read_b128 v[32:35], v109 offset:7680
  s_mov_b64 exec, -1
  v_exp_f32 v42, v42
  v_exp_f32 v43, v43
  v_cvt_pk_bf16_f32 v70, v40, v41
  v_exp_f32 v44, v44
  v_cvt_pk_bf16_f32 v71, v42, v43
  v_exp_f32 v45, v45
  v_exp_f32 v46, v46
  v_mfma_f32_32x32x16_bf16 v[76:91], v[20:23], v[68:71], v[76:91]
  v_exp_f32 v47, v47
  v_cvt_pk_bf16_f32 v72, v44, v45
  v_exp_f32 v48, v48
  v_exp_f32 v49, v49
  v_cvt_pk_bf16_f32 v73, v46, v47
  v_exp_f32 v50, v50
  v_exp_f32 v51, v51
  v_cvt_pk_bf16_f32 v74, v48, v49
  v_cvt_pk_bf16_f32 v75, v50, v51
  v_exp_f32 v52, v52
  v_exp_f32 v53, v53
  v_mfma_f32_32x32x16_bf16 v[76:91], v[24:27], v[72:75], v[76:91]
  v_exp_f32 v54, v54
  v_exp_f32 v55, v55
  v_cvt_pk_bf16_f32 v68, v52, v53
  v_exp_f32 v56, v56
  v_exp_f32 v57, v57
  v_cvt_pk_bf16_f32 v69, v54, v55
  s_waitcnt lgkmcnt(0)
  v_mfma_f32_32x32x16_bf16 v[36:51], v[16:19], v[4:7], 0
  v_exp_f32 v58, v58
  v_exp_f32 v59, v59
  v_cvt_pk_bf16_f32 v70, v56, v57
  v_exp_f32 v60, v60
  v_cvt_pk_bf16_f32 v71, v58, v59
  v_exp_f32 v61, v61
  v_exp_f32 v62, v62
  v_mfma_f32_32x32x16_bf16 v[92:107], v[20:23], v[68:71], v[92:107]
  v_exp_f32 v63, v63
  v_cvt_pk_bf16_f32 v72, v60, v61
  v_exp_f32 v64, v64
  v_exp_f32 v65, v65
  v_cvt_pk_bf16_f32 v73, v62, v63
  v_exp_f32 v66, v66
  v_exp_f32 v67, v67
  v_cvt_pk_bf16_f32 v74, v64, v65
  v_cvt_pk_bf16_f32 v75, v66, v67
  v_exp_f32 v36, v36
  v_exp_f32 v37, v37
  v_mfma_f32_32x32x16_bf16 v[92:107], v[24:27], v[72:75], v[92:107]
  v_exp_f32 v38, v38
  v_exp_f32 v39, v39
  v_cvt_pk_bf16_f32 v68, v36, v37
  v_exp_f32 v40, v40
  v_exp_f32 v41, v41
  v_cvt_pk_bf16_f32 v69, v38, v39
  v_mfma_f32_32x32x16_bf16 v[52:67], v[16:19], v[8:11], 0
  ds_read_b128 v[12:15], v108 offset:8192
  s_mov_b64 exec, s[60:61]
  ds_read_b128 v[20:23], v109 offset:8192
  ds_read_b128 v[24:27], v109 offset:8704
  s_mov_b64 exec, -1
  v_exp_f32 v42, v42
  v_exp_f32 v43, v43
  v_cvt_pk_bf16_f32 v70, v40, v41
  v_exp_f32 v44, v44
  v_cvt_pk_bf16_f32 v71, v42, v43
  v_exp_f32 v45, v45
  v_exp_f32 v46, v46
  v_mfma_f32_32x32x16_bf16 v[76:91], v[28:31], v[68:71], v[76:91]
  v_exp_f32 v47, v47
  v_cvt_pk_bf16_f32 v72, v44, v45
  v_exp_f32 v48, v48
  v_exp_f32 v49, v49
  v_cvt_pk_bf16_f32 v73, v46, v47
  v_exp_f32 v50, v50
  v_exp_f32 v51, v51
  v_cvt_pk_bf16_f32 v74, v48, v49
  v_cvt_pk_bf16_f32 v75, v50, v51
  v_exp_f32 v52, v52
  v_exp_f32 v53, v53
  v_mfma_f32_32x32x16_bf16 v[76:91], v[32:35], v[72:75], v[76:91]
  v_exp_f32 v54, v54
  v_exp_f32 v55, v55
  v_cvt_pk_bf16_f32 v68, v52, v53
  v_exp_f32 v56, v56
  v_exp_f32 v57, v57
  v_cvt_pk_bf16_f32 v69, v54, v55
  s_waitcnt lgkmcnt(0)
  v_mfma_f32_32x32x16_bf16 v[36:51], v[12:15], v[4:7], 0
  v_exp_f32 v58, v58
  v_exp_f32 v59, v59
  v_cvt_pk_bf16_f32 v70, v56, v57
  v_exp_f32 v60, v60
  v_cvt_pk_bf16_f32 v71, v58, v59
  v_exp_f32 v61, v61
  v_exp_f32 v62, v62
  v_mfma_f32_32x32x16_bf16 v[92:107], v[28:31], v[68:71], v[92:107]
  v_exp_f32 v63, v63
  v_cvt_pk_bf16_f32 v72, v60, v61
  v_exp_f32 v64, v64
  v_exp_f32 v65, v65
  v_cvt_pk_bf16_f32 v73, v62, v63
  v_exp_f32 v66, v66
  v_exp_f32 v67, v67
  v_cvt_pk_bf16_f32 v74, v64, v65
  v_cvt_pk_bf16_f32 v75, v66, v67
  s_cmp_lt_u32 s3, 4
  s_cbranch_scc1 sequential_preLN__mha_block__dense_activation_squared_relu__prompt_kernel_yg_58
  v_lshlrev_b32 v1, 4, v0
  v_lshrrev_b32 v2, 5, v0
  v_bfe_u32 v3, v0, 2, 2
  v_lshl_add_u32 v2, v2, 2, v3
  v_lshlrev_b32 v2, 6, v2
  v_bfe_u32 v3, v0, 4, 1
  v_lshl_add_u32 v2, v3, 5, v2
  v_and_b32 v3, 3, v0
  v_lshl_add_u32 v2, v3, 3, v2
  s_and_b32 s57, s3, 3
  s_lshl_b32 s57, s57, 12
  s_add_u32 s57, s57, 131072
  v_add_u32 v2, s57, v2
  s_waitcnt vmcnt(0)
  ds_read_b64_tr_b16 v[128:129], v2 offset:0
  ds_read_b64_tr_b16 v[130:131], v2 offset:512
  ds_read_b64_tr_b16 v[132:133], v2 offset:1024
  ds_read_b64_tr_b16 v[134:135], v2 offset:1536
  ds_read_b64_tr_b16 v[136:137], v2 offset:2048
  ds_read_b64_tr_b16 v[138:139], v2 offset:2560
  ds_read_b64_tr_b16 v[140:141], v2 offset:3072
  ds_read_b64_tr_b16 v[142:143], v2 offset:3584
  s_add_u32 s62, s7, 0
  s_lshl_b32 s56, s62, 10
  s_add_u32 s56, s56, 24117248
  buffer_store_dwordx4 v[160:163], v1, s[8:11], s56 offen sc1
  s_add_u32 s62, s7, 1
  s_lshl_b32 s56, s62, 10
  s_add_u32 s56, s56, 24117248
  buffer_store_dwordx4 v[164:167], v1, s[8:11], s56 offen sc1
  s_waitcnt lgkmcnt(0)
  s_add_u32 s62, s7, 0
  buffer_store_dwordx4 v[128:131], v1, s[8:11], s98 offen sc1
  s_cmp_ge_u32 s62, 1216
  s_cbranch_scc1 sequential_preLN__mha_block__dense_activation_squared_relu__prompt_kernel_rs_59
  buffer_store_dwordx4 v[132:135], v1, s[8:11], s99 offen sc1
sequential_preLN__mha_block__dense_activation_squared_relu__prompt_kernel_rs_59:
  s_add_u32 s62, s7, 1
  buffer_store_dwordx4 v[136:139], v1, s[8:11], s100 offen sc1
  s_cmp_ge_u32 s62, 1216
  s_cbranch_scc1 sequential_preLN__mha_block__dense_activation_squared_relu__prompt_kernel_rs_60
  buffer_store_dwordx4 v[140:143], v1, s[8:11], s101 offen sc1
sequential_preLN__mha_block__dense_activation_squared_relu__prompt_kernel_rs_60:
sequential_preLN__mha_block__dense_activation_squared_relu__prompt_kernel_yg_58:
  v_add_u32 v108, 8192, v108
  v_add_u32 v109, 8192, v109
  s_mov_b32 s62, 5
  .p2align 3
sequential_preLN__mha_block__dense_activation_squared_relu__prompt_kernel_B_loop:
  v_exp_f32 v36, v36
  v_exp_f32 v37, v37
  v_mfma_f32_32x32x16_bf16 v[92:107], v[32:35], v[72:75], v[92:107]
  v_exp_f32 v38, v38
  v_exp_f32 v39, v39
  v_cvt_pk_bf16_f32 v68, v36, v37
  v_exp_f32 v40, v40
  v_exp_f32 v41, v41
  v_cvt_pk_bf16_f32 v69, v38, v39
  v_mfma_f32_32x32x16_bf16 v[52:67], v[12:15], v[8:11], 0
  ds_read_b128 v[16:19], v108 offset:1024
  s_mov_b64 exec, s[60:61]
  ds_read_b128 v[28:31], v109 offset:1024
  ds_read_b128 v[32:35], v109 offset:1536
  s_mov_b64 exec, -1
  v_exp_f32 v42, v42
  v_exp_f32 v43, v43
  v_cvt_pk_bf16_f32 v70, v40, v41
  v_exp_f32 v44, v44
  v_cvt_pk_bf16_f32 v71, v42, v43
  v_exp_f32 v45, v45
  v_exp_f32 v46, v46
  v_mfma_f32_32x32x16_bf16 v[76:91], v[20:23], v[68:71], v[76:91]
  v_exp_f32 v47, v47
  v_cvt_pk_bf16_f32 v72, v44, v45
  v_exp_f32 v48, v48
  v_exp_f32 v49, v49
  v_cvt_pk_bf16_f32 v73, v46, v47
  v_exp_f32 v50, v50
  v_exp_f32 v51, v51
  v_cvt_pk_bf16_f32 v74, v48, v49
  v_cvt_pk_bf16_f32 v75, v50, v51
  v_exp_f32 v52, v52
  v_exp_f32 v53, v53
  v_mfma_f32_32x32x16_bf16 v[76:91], v[24:27], v[72:75], v[76:91]
  v_exp_f32 v54, v54
  v_exp_f32 v55, v55
  v_cvt_pk_bf16_f32 v68, v52, v53
  v_exp_f32 v56, v56
  v_exp_f32 v57, v57
  v_cvt_pk_bf16_f32 v69, v54, v55
  s_waitcnt lgkmcnt(0)
  v_mfma_f32_32x32x16_bf16 v[36:51], v[16:19], v[4:7], 0
  v_exp_f32 v58, v58
  v_exp_f32 v59, v59
  v_cvt_pk_bf16_f32 v70, v56, v57
  v_exp_f32 v60, v60
  v_cvt_pk_bf16_f32 v71, v58, v59
  v_exp_f32 v61, v61
  v_exp_f32 v62, v62
  v_mfma_f32_32x32x16_bf16 v[92:107], v[20:23], v[68:71], v[92:107]
  v_exp_f32 v63, v63
  v_cvt_pk_bf16_f32 v72, v60, v61
  v_exp_f32 v64, v64
  v_exp_f32 v65, v65
  v_cvt_pk_bf16_f32 v73, v62, v63
  v_exp_f32 v66, v66
  v_exp_f32 v67, v67
  v_cvt_pk_bf16_f32 v74, v64, v65
  v_cvt_pk_bf16_f32 v75, v66, v67
  v_exp_f32 v36, v36
  v_exp_f32 v37, v37
  v_mfma_f32_32x32x16_bf16 v[92:107], v[24:27], v[72:75], v[92:107]
  v_exp_f32 v38, v38
  v_exp_f32 v39, v39
  v_cvt_pk_bf16_f32 v68, v36, v37
  v_exp_f32 v40, v40
  v_exp_f32 v41, v41
  v_cvt_pk_bf16_f32 v69, v38, v39
  v_mfma_f32_32x32x16_bf16 v[52:67], v[16:19], v[8:11], 0
  ds_read_b128 v[12:15], v108 offset:2048
  s_mov_b64 exec, s[60:61]
  ds_read_b128 v[20:23], v109 offset:2048
  ds_read_b128 v[24:27], v109 offset:2560
  s_mov_b64 exec, -1
  v_exp_f32 v42, v42
  v_exp_f32 v43, v43
  v_cvt_pk_bf16_f32 v70, v40, v41
  v_exp_f32 v44, v44
  v_cvt_pk_bf16_f32 v71, v42, v43
  v_exp_f32 v45, v45
  v_exp_f32 v46, v46
  v_mfma_f32_32x32x16_bf16 v[76:91], v[28:31], v[68:71], v[76:91]
  v_exp_f32 v47, v47
  v_cvt_pk_bf16_f32 v72, v44, v45
  v_exp_f32 v48, v48
  v_exp_f32 v49, v49
  v_cvt_pk_bf16_f32 v73, v46, v47
  v_exp_f32 v50, v50
  v_exp_f32 v51, v51
  v_cvt_pk_bf16_f32 v74, v48, v49
  v_cvt_pk_bf16_f32 v75, v50, v51
  v_exp_f32 v52, v52
  v_exp_f32 v53, v53
  v_mfma_f32_32x32x16_bf16 v[76:91], v[32:35], v[72:75], v[76:91]
  v_exp_f32 v54, v54
  v_exp_f32 v55, v55
  v_cvt_pk_bf16_f32 v68, v52, v53
  v_exp_f32 v56, v56
  v_exp_f32 v57, v57
  v_cvt_pk_bf16_f32 v69, v54, v55
  s_waitcnt lgkmcnt(0)
  v_mfma_f32_32x32x16_bf16 v[36:51], v[12:15], v[4:7], 0
  v_exp_f32 v58, v58
  v_exp_f32 v59, v59
  v_cvt_pk_bf16_f32 v70, v56, v57
  v_exp_f32 v60, v60
  v_cvt_pk_bf16_f32 v71, v58, v59
  v_exp_f32 v61, v61
  v_exp_f32 v62, v62
  v_mfma_f32_32x32x16_bf16 v[92:107], v[28:31], v[68:71], v[92:107]
  v_exp_f32 v63, v63
  v_cvt_pk_bf16_f32 v72, v60, v61
  v_exp_f32 v64, v64
  v_exp_f32 v65, v65
  v_cvt_pk_bf16_f32 v73, v62, v63
  v_exp_f32 v66, v66
  v_exp_f32 v67, v67
  v_cvt_pk_bf16_f32 v74, v64, v65
  v_cvt_pk_bf16_f32 v75, v66, v67
  v_exp_f32 v36, v36
  v_exp_f32 v37, v37
  v_mfma_f32_32x32x16_bf16 v[92:107], v[32:35], v[72:75], v[92:107]
  v_exp_f32 v38, v38
  v_exp_f32 v39, v39
  v_cvt_pk_bf16_f32 v68, v36, v37
  v_exp_f32 v40, v40
  v_exp_f32 v41, v41
  v_cvt_pk_bf16_f32 v69, v38, v39
  v_mfma_f32_32x32x16_bf16 v[52:67], v[12:15], v[8:11], 0
  ds_read_b128 v[16:19], v108 offset:3072
  s_mov_b64 exec, s[60:61]
  ds_read_b128 v[28:31], v109 offset:3072
  ds_read_b128 v[32:35], v109 offset:3584
  s_mov_b64 exec, -1
  v_exp_f32 v42, v42
  v_exp_f32 v43, v43
  v_cvt_pk_bf16_f32 v70, v40, v41
  v_exp_f32 v44, v44
  v_cvt_pk_bf16_f32 v71, v42, v43
  v_exp_f32 v45, v45
  v_exp_f32 v46, v46
  v_mfma_f32_32x32x16_bf16 v[76:91], v[20:23], v[68:71], v[76:91]
  v_exp_f32 v47, v47
  v_cvt_pk_bf16_f32 v72, v44, v45
  v_exp_f32 v48, v48
  v_exp_f32 v49, v49
  v_cvt_pk_bf16_f32 v73, v46, v47
  v_exp_f32 v50, v50
  v_exp_f32 v51, v51
  v_cvt_pk_bf16_f32 v74, v48, v49
  v_cvt_pk_bf16_f32 v75, v50, v51
  v_exp_f32 v52, v52
  v_exp_f32 v53, v53
  v_mfma_f32_32x32x16_bf16 v[76:91], v[24:27], v[72:75], v[76:91]
  v_exp_f32 v54, v54
  v_exp_f32 v55, v55
  v_cvt_pk_bf16_f32 v68, v52, v53
  v_exp_f32 v56, v56
  v_exp_f32 v57, v57
  v_cvt_pk_bf16_f32 v69, v54, v55
  s_waitcnt lgkmcnt(0)
  v_mfma_f32_32x32x16_bf16 v[36:51], v[16:19], v[4:7], 0
  v_exp_f32 v58, v58
  v_exp_f32 v59, v59
  v_cvt_pk_bf16_f32 v70, v56, v57
  v_exp_f32 v60, v60
  v_cvt_pk_bf16_f32 v71, v58, v59
  v_exp_f32 v61, v61
  v_exp_f32 v62, v62
  v_mfma_f32_32x32x16_bf16 v[92:107], v[20:23], v[68:71], v[92:107]
  v_exp_f32 v63, v63
  v_cvt_pk_bf16_f32 v72, v60, v61
  v_exp_f32 v64, v64
  v_exp_f32 v65, v65
  v_cvt_pk_bf16_f32 v73, v62, v63
  v_exp_f32 v66, v66
  v_exp_f32 v67, v67
  v_cvt_pk_bf16_f32 v74, v64, v65
  v_cvt_pk_bf16_f32 v75, v66, v67
  v_exp_f32 v36, v36
  v_exp_f32 v37, v37
  v_mfma_f32_32x32x16_bf16 v[92:107], v[24:27], v[72:75], v[92:107]
  v_exp_f32 v38, v38
  v_exp_f32 v39, v39
  v_cvt_pk_bf16_f32 v68, v36, v37
  v_exp_f32 v40, v40
  v_exp_f32 v41, v41
  v_cvt_pk_bf16_f32 v69, v38, v39
  v_mfma_f32_32x32x16_bf16 v[52:67], v[16:19], v[8:11], 0
  ds_read_b128 v[12:15], v108 offset:4096
  s_mov_b64 exec, s[60:61]
  ds_read_b128 v[20:23], v109 offset:4096
  ds_read_b128 v[24:27], v109 offset:4608
  s_mov_b64 exec, -1
  v_exp_f32 v42, v42
  v_exp_f32 v43, v43
  v_cvt_pk_bf16_f32 v70, v40, v41
  v_exp_f32 v44, v44
  v_cvt_pk_bf16_f32 v71, v42, v43
  v_exp_f32 v45, v45
  v_exp_f32 v46, v46
  v_mfma_f32_32x32x16_bf16 v[76:91], v[28:31], v[68:71], v[76:91]
  v_exp_f32 v47, v47
  v_cvt_pk_bf16_f32 v72, v44, v45
  v_exp_f32 v48, v48
  v_exp_f32 v49, v49
  v_cvt_pk_bf16_f32 v73, v46, v47
  v_exp_f32 v50, v50
  v_exp_f32 v51, v51
  v_cvt_pk_bf16_f32 v74, v48, v49
  v_cvt_pk_bf16_f32 v75, v50, v51
  v_exp_f32 v52, v52
  v_exp_f32 v53, v53
  v_mfma_f32_32x32x16_bf16 v[76:91], v[32:35], v[72:75], v[76:91]
  v_exp_f32 v54, v54
  v_exp_f32 v55, v55
  v_cvt_pk_bf16_f32 v68, v52, v53
  v_exp_f32 v56, v56
  v_exp_f32 v57, v57
  v_cvt_pk_bf16_f32 v69, v54, v55
  s_waitcnt lgkmcnt(0)
  v_mfma_f32_32x32x16_bf16 v[36:51], v[12:15], v[4:7], 0
  v_exp_f32 v58, v58
  v_exp_f32 v59, v59
  v_cvt_pk_bf16_f32 v70, v56, v57
  v_exp_f32 v60, v60
  v_cvt_pk_bf16_f32 v71, v58, v59
  v_exp_f32 v61, v61
  v_exp_f32 v62, v62
  v_mfma_f32_32x32x16_bf16 v[92:107], v[28:31], v[68:71], v[92:107]
  v_exp_f32 v63, v63
  v_cvt_pk_bf16_f32 v72, v60, v61
  v_exp_f32 v64, v64
  v_exp_f32 v65, v65
  v_cvt_pk_bf16_f32 v73, v62, v63
  v_exp_f32 v66, v66
  v_exp_f32 v67, v67
  v_cvt_pk_bf16_f32 v74, v64, v65
  v_cvt_pk_bf16_f32 v75, v66, v67
  v_add_u32 v108, 4096, v108
  v_add_u32 v109, 4096, v109
  s_sub_u32 s62, s62, 1
  s_cmp_eq_u32 s62, 4
  s_cbranch_scc0 sequential_preLN__mha_block__dense_activation_squared_relu__prompt_kernel_nf_61
  s_cmp_ge_u32 s3, 4
  s_cbranch_scc0 sequential_preLN__mha_block__dense_activation_squared_relu__prompt_kernel_nf_61
  s_waitcnt vmcnt(0)
  v_mov_b32 v2, 149508
  v_mov_b32 v3, 1
  s_mov_b64 exec, 1
  ds_add_rtn_u32 v3, v2, v3
  s_waitcnt lgkmcnt(0)
  s_mov_b64 exec, -1
  v_readfirstlane_b32 s56, v3
  s_cmp_eq_u32 s56, 3
  s_cbranch_scc0 sequential_preLN__mha_block__dense_activation_squared_relu__prompt_kernel_nf_61
  s_lshl_b32 s56, s2, 7
  s_add_u32 s56, s56, 23199744
  v_mov_b32 v2, 0
  v_mov_b32 v3, s4
  s_mov_b64 exec, 1
  buffer_store_dword v3, v2, s[8:11], s56 offen sc1
  s_mov_b64 exec, -1
sequential_preLN__mha_block__dense_activation_squared_relu__prompt_kernel_nf_61:
  s_cmp_eq_u32 s3, 4
  s_cbranch_scc0 sequential_preLN__mha_block__dense_activation_squared_relu__prompt_kernel_w4_62
  s_cmp_eq_u32 s62, 3
  s_cbranch_scc0 sequential_preLN__mha_block__dense_activation_squared_relu__prompt_kernel_w4b_63
  v_lshlrev_b32 v2, 7, v0
  s_mov_b32 s56, 23199744
  buffer_load_dword v124, v2, s[8:11], s56 offen sc1
  s_mov_b32 s56, 23207936
  buffer_load_dword v125, v2, s[8:11], s56 offen sc1
  s_mov_b32 s56, 23216128
  buffer_load_dword v126, v2, s[8:11], s56 offen sc1
  s_mov_b32 s56, 23224320
  buffer_load_dword v127, v2, s[8:11], s56 offen sc1
sequential_preLN__mha_block__dense_activation_squared_relu__prompt_kernel_w4b_63:
  s_cmp_eq_u32 s62, 2
  s_cbranch_scc0 sequential_preLN__mha_block__dense_activation_squared_relu__prompt_kernel_w4_62
  s_mov_b32 s58, 0
  v_lshlrev_b32 v2, 7, v0
sequential_preLN__mha_block__dense_activation_squared_relu__prompt_kernel_fw_64:
  s_waitcnt vmcnt(0)
  v_cmp_eq_u32 vcc, s4, v124
  v_cmp_eq_u32 s[56:57], s4, v125
  s_and_b64 vcc, vcc, s[56:57]
  v_cmp_eq_u32 s[56:57], s4, v126
  s_and_b64 vcc, vcc, s[56:57]
  v_cmp_eq_u32 s[56:57], s4, v127
  s_and_b64 vcc, vcc, s[56:57]
  s_add_u32 s58, s58, 1
  s_cmp_eq_u64 vcc, -1
  s_cbranch_scc1 sequential_preLN__mha_block__dense_activation_squared_relu__prompt_kernel_fwd_65
  s_cmp_gt_u32 s58, 200000
  s_cbranch_scc1 sequential_preLN__mha_block__dense_activation_squared_relu__prompt_kernel_fwd_65
  s_mov_b32 s56, 23199744
  buffer_load_dword v124, v2, s[8:11], s56 offen sc1
  s_mov_b32 s56, 23207936
  buffer_load_dword v125, v2, s[8:11], s56 offen sc1
  s_mov_b32 s56, 23216128
  buffer_load_dword v126, v2, s[8:11], s56 offen sc1
  s_mov_b32 s56, 23224320
  buffer_load_dword v127, v2, s[8:11], s56 offen sc1
  s_branch sequential_preLN__mha_block__dense_activation_squared_relu__prompt_kernel_fw_64
sequential_preLN__mha_block__dense_activation_squared_relu__prompt_kernel_fwd_65:
  v_mov_b32 v2, 149512
  v_mov_b32 v3, 1
  ds_write_b32 v2, v3
sequential_preLN__mha_block__dense_activation_squared_relu__prompt_kernel_w4_62:
  s_cmp_eq_u32 s62, 0
  s_cbranch_scc0 sequential_preLN__mha_block__dense_activation_squared_relu__prompt_kernel_np_66
  s_setprio 0
sequential_preLN__mha_block__dense_activation_squared_relu__prompt_kernel_np_66:
  s_cmp_lg_u32 s62, 1
  s_cbranch_scc1 sequential_preLN__mha_block__dense_activation_squared_relu__prompt_kernel_B_loop
  s_mov_b32 s58, 0
  v_mov_b32 v2, 149512
sequential_preLN__mha_block__dense_activation_squared_relu__prompt_kernel_wr_67:
  ds_read_b32 v3, v2
  s_add_u32 s58, s58, 1
  s_waitcnt lgkmcnt(0)
  v_readfirstlane_b32 s56, v3
  s_cmp_gt_u32 s58, 12800000
  s_cbranch_scc1 sequential_preLN__mha_block__dense_activation_squared_relu__prompt_kernel_wrd_68
  s_cmp_eq_u32 s56, 0
  s_cbranch_scc1 sequential_preLN__mha_block__dense_activation_squared_relu__prompt_kernel_wr_67
sequential_preLN__mha_block__dense_activation_squared_relu__prompt_kernel_wrd_68:
  s_cmp_ge_u32 s3, 4
  s_cbranch_scc0 sequential_preLN__mha_block__dense_activation_squared_relu__prompt_kernel_tch2_69
  s_lshr_b32 s56, s2, 4
  s_mul_i32 s57, s56, 3
  s_lshl_b32 s63, s56, 1
  s_add_u32 s63, s63, 11
  s_cmp_lt_u32 s56, 11
  s_cselect_b32 s57, s57, s63
  s_lshl_b32 s57, s57, 15
  s_add_u32 s57, s57, 18874368
  s_sub_u32 s56, s3, 4
  s_lshl_b32 s56, s56, 13
  s_add_u32 s57, s57, s56
  v_lshlrev_b32 v2, 7, v0
  buffer_load_dword v216, v2, s[8:11], s57 offen
  s_add_u32 s57, s57, 32768
  buffer_load_dword v217, v2, s[8:11], s57 offen
  s_add_u32 s57, s57, 32768
  buffer_load_dword v218, v2, s[8:11], s57 offen
  s_add_u32 s57, s57, 32768
  s_mov_b32 s20, s34
  s_and_b32 s21, s35, 0xffff
  s_mov_b32 s22, 2752
  s_mov_b32 s23, 0x20000
  buffer_load_dword v221, v2, s[20:23], 0 offen
  s_mov_b32 s20, s38
  s_and_b32 s21, s39, 0xffff
  s_mov_b32 s22, 1024
  s_mov_b32 s23, 0x20000
  buffer_load_dword v222, v2, s[20:23], 0 offen
sequential_preLN__mha_block__dense_activation_squared_relu__prompt_kernel_tch2_69:
  s_lshr_b32 s6, s2, 5
  s_and_b32 s62, s3, 1
  s_lshr_b32 s63, s3, 1
  s_lshl_b32 s54, s6, 1
  s_add_u32 s54, s54, s62
  s_mul_i32 s54, s54, 86
  s_mul_i32 s62, s63, 22
  s_add_u32 s54, s54, s62
  s_lshl_b32 s54, s54, 10
  s_add_u32 s54, s54, 20971520
  v_exp_f32 v36, v36
  v_exp_f32 v37, v37
  v_mfma_f32_32x32x16_bf16 v[92:107], v[32:35], v[72:75], v[92:107]
  v_exp_f32 v38, v38
  v_exp_f32 v39, v39
  v_cvt_pk_bf16_f32 v68, v36, v37
  v_exp_f32 v40, v40
  v_exp_f32 v41, v41
  v_cvt_pk_bf16_f32 v69, v38, v39
  v_mfma_f32_32x32x16_bf16 v[52:67], v[12:15], v[8:11], 0
  ds_read_b128 v[16:19], v108 offset:1024
  s_mov_b64 exec, s[60:61]
  ds_read_b128 v[28:31], v109 offset:1024
  ds_read_b128 v[32:35], v109 offset:1536
  s_mov_b64 exec, -1
  v_exp_f32 v42, v42
  v_exp_f32 v43, v43
  v_cvt_pk_bf16_f32 v70, v40, v41
  v_exp_f32 v44, v44
  v_cvt_pk_bf16_f32 v71, v42, v43
  v_exp_f32 v45, v45
  v_exp_f32 v46, v46
  v_mfma_f32_32x32x16_bf16 v[76:91], v[20:23], v[68:71], v[76:91]
  buffer_load_dwordx4 v[128:131], v1, s[8:11], s54 offen offset:0 sc1
  buffer_load_dwordx4 v[132:135], v1, s[8:11], s54 offen offset:1024 sc1
  v_exp_f32 v47, v47
  v_cvt_pk_bf16_f32 v72, v44, v45
  v_exp_f32 v48, v48
  v_exp_f32 v49, v49
  v_cvt_pk_bf16_f32 v73, v46, v47
  v_exp_f32 v50, v50
  v_exp_f32 v51, v51
  v_cvt_pk_bf16_f32 v74, v48, v49
  v_cvt_pk_bf16_f32 v75, v50, v51
  v_exp_f32 v52, v52
  v_exp_f32 v53, v53
  v_mfma_f32_32x32x16_bf16 v[76:91], v[24:27], v[72:75], v[76:91]
  v_exp_f32 v54, v54
  v_exp_f32 v55, v55
  v_cvt_pk_bf16_f32 v68, v52, v53
  v_exp_f32 v56, v56
  v_exp_f32 v57, v57
  v_cvt_pk_bf16_f32 v69, v54, v55
  s_waitcnt lgkmcnt(0)
  v_mfma_f32_32x32x16_bf16 v[36:51], v[16:19], v[4:7], 0
  v_exp_f32 v58, v58
  v_exp_f32 v59, v59
  v_cvt_pk_bf16_f32 v70, v56, v57
  v_exp_f32 v60, v60
  v_cvt_pk_bf16_f32 v71, v58, v59
  v_exp_f32 v61, v61
  v_exp_f32 v62, v62
  v_mfma_f32_32x32x16_bf16 v[92:107], v[20:23], v[68:71], v[92:107]
  buffer_load_dwordx4 v[136:139], v1, s[8:11], s54 offen offset:2048 sc1
  buffer_load_dwordx4 v[140:143], v1, s[8:11], s54 offen offset:3072 sc1
  v_exp_f32 v63, v63
  v_cvt_pk_bf16_f32 v72, v60, v61
  v_exp_f32 v64, v64
  v_exp_f32 v65, v65
  v_cvt_pk_bf16_f32 v73, v62, v63
  v_exp_f32 v66, v66
  v_exp_f32 v67, v67
  v_cvt_pk_bf16_f32 v74, v64, v65
  v_cvt_pk_bf16_f32 v75, v66, v67
  v_exp_f32 v36, v36
  v_exp_f32 v37, v37
  v_mfma_f32_32x32x16_bf16 v[92:107], v[24:27], v[72:75], v[92:107]
  v_exp_f32 v38, v38
  v_exp_f32 v39, v39
  v_cvt_pk_bf16_f32 v68, v36, v37
  v_exp_f32 v40, v40
  v_exp_f32 v41, v41
  v_cvt_pk_bf16_f32 v69, v38, v39
  v_mfma_f32_32x32x16_bf16 v[52:67], v[16:19], v[8:11], 0
  ds_read_b128 v[12:15], v108 offset:2048
  s_mov_b64 exec, s[60:61]
  ds_read_b128 v[20:23], v109 offset:2048
  ds_read_b128 v[24:27], v109 offset:2560
  s_mov_b64 exec, -1
  v_exp_f32 v42, v42
  v_exp_f32 v43, v43
  v_cvt_pk_bf16_f32 v70, v40, v41
  v_exp_f32 v44, v44
  v_cvt_pk_bf16_f32 v71, v42, v43
  v_exp_f32 v45, v45
  v_exp_f32 v46, v46
  v_mfma_f32_32x32x16_bf16 v[76:91], v[28:31], v[68:71], v[76:91]
  s_add_u32 s54, s54, 4096
  buffer_load_dwordx4 v[144:147], v1, s[8:11], s54 offen offset:0 sc1
  buffer_load_dwordx4 v[148:151], v1, s[8:11], s54 offen offset:1024 sc1
  v_exp_f32 v47, v47
  v_cvt_pk_bf16_f32 v72, v44, v45
  v_exp_f32 v48, v48
  v_exp_f32 v49, v49
  v_cvt_pk_bf16_f32 v73, v46, v47
  v_exp_f32 v50, v50
  v_exp_f32 v51, v51
  v_cvt_pk_bf16_f32 v74, v48, v49
  v_cvt_pk_bf16_f32 v75, v50, v51
  v_exp_f32 v52, v52
  v_exp_f32 v53, v53
  v_mfma_f32_32x32x16_bf16 v[76:91], v[32:35], v[72:75], v[76:91]
  v_exp_f32 v54, v54
  v_exp_f32 v55, v55
  v_cvt_pk_bf16_f32 v68, v52, v53
  v_exp_f32 v56, v56
  v_exp_f32 v57, v57
  v_cvt_pk_bf16_f32 v69, v54, v55
  s_waitcnt lgkmcnt(0)
  v_mfma_f32_32x32x16_bf16 v[36:51], v[12:15], v[4:7], 0
  v_exp_f32 v58, v58
  v_exp_f32 v59, v59
  v_cvt_pk_bf16_f32 v70, v56, v57
  v_exp_f32 v60, v60
  v_cvt_pk_bf16_f32 v71, v58, v59
  v_exp_f32 v61, v61
  v_exp_f32 v62, v62
  v_mfma_f32_32x32x16_bf16 v[92:107], v[28:31], v[68:71], v[92:107]
  buffer_load_dwordx4 v[152:155], v1, s[8:11], s54 offen offset:2048 sc1
  buffer_load_dwordx4 v[156:159], v1, s[8:11], s54 offen offset:3072 sc1
  v_exp_f32 v63, v63
  v_cvt_pk_bf16_f32 v72, v60, v61
  v_exp_f32 v64, v64
  v_exp_f32 v65, v65
  v_cvt_pk_bf16_f32 v73, v62, v63
  v_exp_f32 v66, v66
  v_exp_f32 v67, v67
  v_cvt_pk_bf16_f32 v74, v64, v65
  v_cvt_pk_bf16_f32 v75, v66, v67
  v_exp_f32 v36, v36
  v_exp_f32 v37, v37
  v_mfma_f32_32x32x16_bf16 v[92:107], v[32:35], v[72:75], v[92:107]
  v_exp_f32 v38, v38
  v_exp_f32 v39, v39
  v_cvt_pk_bf16_f32 v68, v36, v37
  v_exp_f32 v40, v40
  v_exp_f32 v41, v41
  v_cvt_pk_bf16_f32 v69, v38, v39
  v_mfma_f32_32x32x16_bf16 v[52:67], v[12:15], v[8:11], 0
  ds_read_b128 v[16:19], v108 offset:3072
  s_mov_b64 exec, s[60:61]
  ds_read_b128 v[28:31], v109 offset:3072
  ds_read_b128 v[32:35], v109 offset:3584
  s_mov_b64 exec, -1
  v_exp_f32 v42, v42
  v_exp_f32 v43, v43
  v_cvt_pk_bf16_f32 v70, v40, v41
  v_exp_f32 v44, v44
  v_cvt_pk_bf16_f32 v71, v42, v43
  v_exp_f32 v45, v45
  v_exp_f32 v46, v46
  v_mfma_f32_32x32x16_bf16 v[76:91], v[20:23], v[68:71], v[76:91]
  s_add_u32 s54, s54, 4096
  buffer_load_dwordx4 v[160:163], v1, s[8:11], s54 offen offset:0 sc1
  buffer_load_dwordx4 v[164:167], v1, s[8:11], s54 offen offset:1024 sc1
  v_exp_f32 v47, v47
  v_cvt_pk_bf16_f32 v72, v44, v45
  v_exp_f32 v48, v48
  v_exp_f32 v49, v49
  v_cvt_pk_bf16_f32 v73, v46, v47
  v_exp_f32 v50, v50
  v_exp_f32 v51, v51
  v_cvt_pk_bf16_f32 v74, v48, v49
  v_cvt_pk_bf16_f32 v75, v50, v51
  v_exp_f32 v52, v52
  v_exp_f32 v53, v53
  v_mfma_f32_32x32x16_bf16 v[76:91], v[24:27], v[72:75], v[76:91]
  v_exp_f32 v54, v54
  v_exp_f32 v55, v55
  v_cvt_pk_bf16_f32 v68, v52, v53
  v_exp_f32 v56, v56
  v_exp_f32 v57, v57
  v_cvt_pk_bf16_f32 v69, v54, v55
  s_waitcnt lgkmcnt(0)
  v_mfma_f32_32x32x16_bf16 v[36:51], v[16:19], v[4:7], 0
  v_exp_f32 v58, v58
  v_exp_f32 v59, v59
  v_cvt_pk_bf16_f32 v70, v56, v57
  v_exp_f32 v60, v60
  v_cvt_pk_bf16_f32 v71, v58, v59
  v_exp_f32 v61, v61
  v_exp_f32 v62, v62
  v_mfma_f32_32x32x16_bf16 v[92:107], v[20:23], v[68:71], v[92:107]
  buffer_load_dwordx4 v[168:171], v1, s[8:11], s54 offen offset:2048 sc1
  buffer_load_dwordx4 v[172:175], v1, s[8:11], s54 offen offset:3072 sc1
  v_exp_f32 v63, v63
  v_cvt_pk_bf16_f32 v72, v60, v61
  v_exp_f32 v64, v64
  v_exp_f32 v65, v65
  v_cvt_pk_bf16_f32 v73, v62, v63
  v_exp_f32 v66, v66
  v_exp_f32 v67, v67
  v_cvt_pk_bf16_f32 v74, v64, v65
  v_cvt_pk_bf16_f32 v75, v66, v67
  v_exp_f32 v36, v36
  v_exp_f32 v37, v37
  v_mfma_f32_32x32x16_bf16 v[92:107], v[24:27], v[72:75], v[92:107]
  v_exp_f32 v38, v38
  v_exp_f32 v39, v39
  v_cvt_pk_bf16_f32 v68, v36, v37
  v_exp_f32 v40, v40
  v_exp_f32 v41, v41
  v_cvt_pk_bf16_f32 v69, v38, v39
  v_mfma_f32_32x32x16_bf16 v[52:67], v[16:19], v[8:11], 0
  ds_read_b128 v[12:15], v108 offset:4096
  s_mov_b64 exec, s[60:61]
  ds_read_b128 v[20:23], v109 offset:4096
  ds_read_b128 v[24:27], v109 offset:4608
  s_mov_b64 exec, -1
  v_exp_f32 v42, v42
  v_exp_f32 v43, v43
  v_cvt_pk_bf16_f32 v70, v40, v41
  v_exp_f32 v44, v44
  v_cvt_pk_bf16_f32 v71, v42, v43
  v_exp_f32 v45, v45
  v_exp_f32 v46, v46
  v_mfma_f32_32x32x16_bf16 v[76:91], v[28:31], v[68:71], v[76:91]
  s_add_u32 s54, s54, 4096
  buffer_load_dwordx4 v[176:179], v1, s[8:11], s54 offen offset:0 sc1
  buffer_load_dwordx4 v[180:183], v1, s[8:11], s54 offen offset:1024 sc1
  v_exp_f32 v47, v47
  v_cvt_pk_bf16_f32 v72, v44, v45
  v_exp_f32 v48, v48
  v_exp_f32 v49, v49
  v_cvt_pk_bf16_f32 v73, v46, v47
  v_exp_f32 v50, v50
  v_exp_f32 v51, v51
  v_cvt_pk_bf16_f32 v74, v48, v49
  v_cvt_pk_bf16_f32 v75, v50, v51
  v_exp_f32 v52, v52
  v_exp_f32 v53, v53
  v_mfma_f32_32x32x16_bf16 v[76:91], v[32:35], v[72:75], v[76:91]
  v_exp_f32 v54, v54
  v_exp_f32 v55, v55
  v_cvt_pk_bf16_f32 v68, v52, v53
  v_exp_f32 v56, v56
  v_exp_f32 v57, v57
  v_cvt_pk_bf16_f32 v69, v54, v55
  s_waitcnt lgkmcnt(0)
  v_mfma_f32_32x32x16_bf16 v[36:51], v[12:15], v[4:7], 0
  v_exp_f32 v58, v58
  v_exp_f32 v59, v59
  v_cvt_pk_bf16_f32 v70, v56, v57
  v_exp_f32 v60, v60
  v_cvt_pk_bf16_f32 v71, v58, v59
  v_exp_f32 v61, v61
  v_exp_f32 v62, v62
  v_mfma_f32_32x32x16_bf16 v[92:107], v[28:31], v[68:71], v[92:107]
  buffer_load_dwordx4 v[184:187], v1, s[8:11], s54 offen offset:2048 sc1
  buffer_load_dwordx4 v[188:191], v1, s[8:11], s54 offen offset:3072 sc1
  v_exp_f32 v63, v63
  v_cvt_pk_bf16_f32 v72, v60, v61
  v_exp_f32 v64, v64
  v_exp_f32 v65, v65
  v_cvt_pk_bf16_f32 v73, v62, v63
  v_exp_f32 v66, v66
  v_exp_f32 v67, v67
  v_cvt_pk_bf16_f32 v74, v64, v65
  v_cvt_pk_bf16_f32 v75, v66, v67
  v_add_u32 v108, 4096, v108
  v_add_u32 v109, 4096, v109
  s_setprio 0
  s_and_b32 s55, s2, 7
  s_lshr_b32 s56, s2, 3
  s_and_b32 s56, s56, 3
  s_lshl_b32 s5, s55, 2
  s_add_u32 s5, s5, s56
  s_lshr_b32 s6, s2, 5
  s_and_b32 s7, s3, 1
  s_bfe_u32 s98, s3, 0x10001
  s_lshr_b32 s99, s3, 2
  s_lshl_b32 s55, s6, 1
  s_add_u32 s55, s55, s98
  s_lshl_b32 s56, s55, 5
  s_lshl_b32 s57, s99, 4
  s_add_u32 s56, s56, s57
  s_lshl_b32 s56, s56, 10
  s_add_u32 s56, s56, 17825792
  s_add_u32 s56, s56, 4096
  s_add_u32 s56, s56, 4096
  s_add_u32 s56, s56, 4096
  s_lshl_b32 s101, s5, 1
  s_add_u32 s101, s101, s7
  s_lshl_b32 s100, s55, 1
  s_add_u32 s100, s100, s99
  s_lshl_b32 s56, s55, 5
  s_lshl_b32 s57, s99, 4
  s_add_u32 s56, s56, s57
  s_lshl_b32 s56, s56, 10
  s_add_u32 s56, s56, 17825792
  v_exp_f32 v36, v36
  v_exp_f32 v37, v37
  v_mfma_f32_32x32x16_bf16 v[92:107], v[32:35], v[72:75], v[92:107]
  v_exp_f32 v38, v38
  v_exp_f32 v39, v39
  v_cvt_pk_bf16_f32 v68, v36, v37
  v_exp_f32 v40, v40
  v_exp_f32 v41, v41
  v_cvt_pk_bf16_f32 v69, v38, v39
  v_mfma_f32_32x32x16_bf16 v[52:67], v[12:15], v[8:11], 0
  ds_read_b128 v[16:19], v108 offset:1024
  s_mov_b64 exec, s[60:61]
  ds_read_b128 v[28:31], v109 offset:1024
  ds_read_b128 v[32:35], v109 offset:1536
  s_mov_b64 exec, -1
  v_exp_f32 v42, v42
  v_exp_f32 v43, v43
  v_cvt_pk_bf16_f32 v70, v40, v41
  v_exp_f32 v44, v44
  v_cvt_pk_bf16_f32 v71, v42, v43
  v_exp_f32 v45, v45
  v_exp_f32 v46, v46
  v_mfma_f32_32x32x16_bf16 v[76:91], v[20:23], v[68:71], v[76:91]
  buffer_load_dwordx4 v[192:195], v1, s[8:11], s56 offen offset:0 sc1
  buffer_load_dwordx4 v[196:199], v1, s[8:11], s56 offen offset:1024 sc1
  v_exp_f32 v47, v47
  v_cvt_pk_bf16_f32 v72, v44, v45
  v_exp_f32 v48, v48
  v_exp_f32 v49, v49
  v_cvt_pk_bf16_f32 v73, v46, v47
  v_exp_f32 v50, v50
  v_exp_f32 v51, v51
  v_cvt_pk_bf16_f32 v74, v48, v49
  v_cvt_pk_bf16_f32 v75, v50, v51
  v_exp_f32 v52, v52
  v_exp_f32 v53, v53
  v_mfma_f32_32x32x16_bf16 v[76:91], v[24:27], v[72:75], v[76:91]
  v_exp_f32 v54, v54
  v_exp_f32 v55, v55
  v_cvt_pk_bf16_f32 v68, v52, v53
  v_exp_f32 v56, v56
  v_exp_f32 v57, v57
  v_cvt_pk_bf16_f32 v69, v54, v55
  s_waitcnt lgkmcnt(0)
  v_mfma_f32_32x32x16_bf16 v[36:51], v[16:19], v[4:7], 0
  v_exp_f32 v58, v58
  v_exp_f32 v59, v59
  v_cvt_pk_bf16_f32 v70, v56, v57
  v_exp_f32 v60, v60
  v_cvt_pk_bf16_f32 v71, v58, v59
  v_exp_f32 v61, v61
  v_exp_f32 v62, v62
  v_mfma_f32_32x32x16_bf16 v[92:107], v[20:23], v[68:71], v[92:107]
  buffer_load_dwordx4 v[200:203], v1, s[8:11], s56 offen offset:2048 sc1
  buffer_load_dwordx4 v[204:207], v1, s[8:11], s56 offen offset:3072 sc1
  v_exp_f32 v63, v63
  v_cvt_pk_bf16_f32 v72, v60, v61
  v_exp_f32 v64, v64
  v_exp_f32 v65, v65
  v_cvt_pk_bf16_f32 v73, v62, v63
  v_exp_f32 v66, v66
  v_exp_f32 v67, v67
  v_cvt_pk_bf16_f32 v74, v64, v65
  v_cvt_pk_bf16_f32 v75, v66, v67
  v_exp_f32 v36, v36
  v_exp_f32 v37, v37
  v_mfma_f32_32x32x16_bf16 v[92:107], v[24:27], v[72:75], v[92:107]
  v_exp_f32 v38, v38
  v_exp_f32 v39, v39
  v_cvt_pk_bf16_f32 v68, v36, v37
  v_exp_f32 v40, v40
  v_exp_f32 v41, v41
  v_cvt_pk_bf16_f32 v69, v38, v39
  v_mfma_f32_32x32x16_bf16 v[52:67], v[16:19], v[8:11], 0
  ds_read_b128 v[12:15], v108 offset:2048
  s_mov_b64 exec, s[60:61]
  ds_read_b128 v[20:23], v109 offset:2048
  ds_read_b128 v[24:27], v109 offset:2560
  s_mov_b64 exec, -1
  v_exp_f32 v42, v42
  v_exp_f32 v43, v43
  v_cvt_pk_bf16_f32 v70, v40, v41
  v_exp_f32 v44, v44
  v_cvt_pk_bf16_f32 v71, v42, v43
  v_exp_f32 v45, v45
  v_exp_f32 v46, v46
  v_mfma_f32_32x32x16_bf16 v[76:91], v[28:31], v[68:71], v[76:91]
  s_add_u32 s56, s56, 4096
  buffer_load_dwordx4 v[208:211], v1, s[8:11], s56 offen offset:0 sc1
  buffer_load_dwordx4 v[212:215], v1, s[8:11], s56 offen offset:1024 sc1
  v_exp_f32 v47, v47
  v_cvt_pk_bf16_f32 v72, v44, v45
  v_exp_f32 v48, v48
  v_exp_f32 v49, v49
  v_cvt_pk_bf16_f32 v73, v46, v47
  v_exp_f32 v50, v50
  v_exp_f32 v51, v51
  v_cvt_pk_bf16_f32 v74, v48, v49
  v_cvt_pk_bf16_f32 v75, v50, v51
  v_exp_f32 v52, v52
  v_exp_f32 v53, v53
  v_mfma_f32_32x32x16_bf16 v[76:91], v[32:35], v[72:75], v[76:91]
  v_exp_f32 v54, v54
  v_exp_f32 v55, v55
  v_cvt_pk_bf16_f32 v68, v52, v53
  v_exp_f32 v56, v56
  v_exp_f32 v57, v57
  v_cvt_pk_bf16_f32 v69, v54, v55
  s_waitcnt lgkmcnt(0)
  v_mfma_f32_32x32x16_bf16 v[36:51], v[12:15], v[4:7], 0
  v_exp_f32 v58, v58
  v_exp_f32 v59, v59
  v_cvt_pk_bf16_f32 v70, v56, v57
  v_exp_f32 v60, v60
  v_cvt_pk_bf16_f32 v71, v58, v59
  v_exp_f32 v61, v61
  v_exp_f32 v62, v62
  v_mfma_f32_32x32x16_bf16 v[92:107], v[28:31], v[68:71], v[92:107]
  buffer_load_dwordx4 v[216:219], v1, s[8:11], s56 offen offset:2048 sc1
  buffer_load_dwordx4 v[220:223], v1, s[8:11], s56 offen offset:3072 sc1
  v_exp_f32 v63, v63
  v_cvt_pk_bf16_f32 v72, v60, v61
  v_exp_f32 v64, v64
  v_exp_f32 v65, v65
  v_cvt_pk_bf16_f32 v73, v62, v63
  v_exp_f32 v66, v66
  v_exp_f32 v67, v67
  v_cvt_pk_bf16_f32 v74, v64, v65
  v_cvt_pk_bf16_f32 v75, v66, v67
  v_exp_f32 v36, v36
  v_exp_f32 v37, v37
  v_mfma_f32_32x32x16_bf16 v[92:107], v[32:35], v[72:75], v[92:107]
  v_exp_f32 v38, v38
  v_exp_f32 v39, v39
  v_cvt_pk_bf16_f32 v68, v36, v37
  v_exp_f32 v40, v40
  v_exp_f32 v41, v41
  v_cvt_pk_bf16_f32 v69, v38, v39
  v_mfma_f32_32x32x16_bf16 v[52:67], v[12:15], v[8:11], 0
  ds_read_b128 v[16:19], v108 offset:3072
  s_mov_b64 exec, s[60:61]
  ds_read_b128 v[28:31], v109 offset:3072
  ds_read_b128 v[32:35], v109 offset:3584
  s_mov_b64 exec, -1
  v_exp_f32 v42, v42
  v_exp_f32 v43, v43
  v_cvt_pk_bf16_f32 v70, v40, v41
  v_exp_f32 v44, v44
  v_cvt_pk_bf16_f32 v71, v42, v43
  v_exp_f32 v45, v45
  v_exp_f32 v46, v46
  v_mfma_f32_32x32x16_bf16 v[76:91], v[20:23], v[68:71], v[76:91]
  s_add_u32 s56, s56, 4096
  buffer_load_dwordx4 v[224:227], v1, s[8:11], s56 offen offset:0 sc1
  buffer_load_dwordx4 v[228:231], v1, s[8:11], s56 offen offset:1024 sc1
  v_exp_f32 v47, v47
  v_cvt_pk_bf16_f32 v72, v44, v45
  v_exp_f32 v48, v48
  v_exp_f32 v49, v49
  v_cvt_pk_bf16_f32 v73, v46, v47
  v_exp_f32 v50, v50
  v_exp_f32 v51, v51
  v_cvt_pk_bf16_f32 v74, v48, v49
  v_cvt_pk_bf16_f32 v75, v50, v51
  v_exp_f32 v52, v52
  v_exp_f32 v53, v53
  v_mfma_f32_32x32x16_bf16 v[76:91], v[24:27], v[72:75], v[76:91]
  v_exp_f32 v54, v54
  v_exp_f32 v55, v55
  v_cvt_pk_bf16_f32 v68, v52, v53
  v_exp_f32 v56, v56
  v_exp_f32 v57, v57
  v_cvt_pk_bf16_f32 v69, v54, v55
  s_waitcnt lgkmcnt(0)
  v_mfma_f32_32x32x16_bf16 v[36:51], v[16:19], v[4:7], 0
  v_exp_f32 v58, v58
  v_exp_f32 v59, v59
  v_cvt_pk_bf16_f32 v70, v56, v57
  v_exp_f32 v60, v60
  v_cvt_pk_bf16_f32 v71, v58, v59
  v_exp_f32 v61, v61
  v_exp_f32 v62, v62
  v_mfma_f32_32x32x16_bf16 v[92:107], v[20:23], v[68:71], v[92:107]
  buffer_load_dwordx4 v[232:235], v1, s[8:11], s56 offen offset:2048 sc1
  buffer_load_dwordx4 v[236:239], v1, s[8:11], s56 offen offset:3072 sc1
  v_exp_f32 v63, v63
  v_cvt_pk_bf16_f32 v72, v60, v61
  v_exp_f32 v64, v64
  v_exp_f32 v65, v65
  v_cvt_pk_bf16_f32 v73, v62, v63
  v_exp_f32 v66, v66
  v_exp_f32 v67, v67
  v_cvt_pk_bf16_f32 v74, v64, v65
  v_cvt_pk_bf16_f32 v75, v66, v67
  v_exp_f32 v36, v36
  v_exp_f32 v37, v37
  v_mfma_f32_32x32x16_bf16 v[92:107], v[24:27], v[72:75], v[92:107]
  v_exp_f32 v38, v38
  v_exp_f32 v39, v39
  v_cvt_pk_bf16_f32 v68, v36, v37
  v_exp_f32 v40, v40
  v_exp_f32 v41, v41
  v_cvt_pk_bf16_f32 v69, v38, v39
  v_mfma_f32_32x32x16_bf16 v[52:67], v[16:19], v[8:11], 0
  v_exp_f32 v42, v42
  v_exp_f32 v43, v43
  v_cvt_pk_bf16_f32 v70, v40, v41
  v_exp_f32 v44, v44
  v_cvt_pk_bf16_f32 v71, v42, v43
  v_exp_f32 v45, v45
  v_exp_f32 v46, v46
  v_mfma_f32_32x32x16_bf16 v[76:91], v[28:31], v[68:71], v[76:91]
  s_add_u32 s56, s56, 4096
  buffer_load_dwordx4 v[240:243], v1, s[8:11], s56 offen offset:0 sc1
  buffer_load_dwordx4 v[244:247], v1, s[8:11], s56 offen offset:1024 sc1
  v_exp_f32 v47, v47
  v_cvt_pk_bf16_f32 v72, v44, v45
  v_exp_f32 v48, v48
  v_exp_f32 v49, v49
  v_cvt_pk_bf16_f32 v73, v46, v47
  v_exp_f32 v50, v50
  v_exp_f32 v51, v51
  v_cvt_pk_bf16_f32 v74, v48, v49
  v_cvt_pk_bf16_f32 v75, v50, v51
  v_exp_f32 v52, v52
  v_exp_f32 v53, v53
  v_mfma_f32_32x32x16_bf16 v[76:91], v[32:35], v[72:75], v[76:91]
  v_exp_f32 v54, v54
  v_exp_f32 v55, v55
  v_cvt_pk_bf16_f32 v68, v52, v53
  v_exp_f32 v56, v56
  v_exp_f32 v57, v57
  v_cvt_pk_bf16_f32 v69, v54, v55
  v_exp_f32 v58, v58
  v_exp_f32 v59, v59
  v_cvt_pk_bf16_f32 v70, v56, v57
  v_exp_f32 v60, v60
  v_cvt_pk_bf16_f32 v71, v58, v59
  v_exp_f32 v61, v61
  v_exp_f32 v62, v62
  v_mfma_f32_32x32x16_bf16 v[92:107], v[28:31], v[68:71], v[92:107]
  buffer_load_dwordx4 v[248:251], v1, s[8:11], s56 offen offset:2048 sc1
  buffer_load_dwordx4 v[252:255], v1, s[8:11], s56 offen offset:3072 sc1
  v_exp_f32 v63, v63
  v_cvt_pk_bf16_f32 v72, v60, v61
  v_exp_f32 v64, v64
  v_exp_f32 v65, v65
  v_cvt_pk_bf16_f32 v73, v62, v63
  v_exp_f32 v66, v66
  v_exp_f32 v67, v67
  v_cvt_pk_bf16_f32 v74, v64, v65
  v_cvt_pk_bf16_f32 v75, v66, v67
  s_nop 1
  v_mfma_f32_32x32x16_bf16 v[92:107], v[32:35], v[72:75], v[92:107]
  s_setprio 0
  s_mul_i32 s54, s3, 2304
  s_add_u32 s54, s54, 131072
  v_add_u32 v3, s54, v1
  v_lshlrev_b32 v2, 2, v0
  v_add_u32 v111, s54, v2
  s_xor_b32 s55, s3, 4
  s_mul_i32 s55, s55, 2304
  s_add_u32 s55, s55, 131072
  v_add_u32 v112, s55, v2
  v_add_u32 v2, s55, v1
  s_nop 11
  s_cmp_eq_u32 s49, 0
  s_cbranch_scc0 sequential_preLN__mha_block__dense_activation_squared_relu__prompt_kernel_kh1_70
  ds_write_b128 v3, v[92:95]
  ds_write_b128 v3, v[96:99] offset:1024
  ds_write_b32 v111, v100 offset:2048
  s_branch sequential_preLN__mha_block__dense_activation_squared_relu__prompt_kernel_khj_71
sequential_preLN__mha_block__dense_activation_squared_relu__prompt_kernel_kh1_70:
  ds_write_b128 v3, v[76:79]
  ds_write_b128 v3, v[80:83] offset:1024
  ds_write_b32 v111, v84 offset:2048
  v_mov_b32 v76, v92
  v_mov_b32 v77, v93
  v_mov_b32 v78, v94
  v_mov_b32 v79, v95
  v_mov_b32 v80, v96
  v_mov_b32 v81, v97
  v_mov_b32 v82, v98
  v_mov_b32 v83, v99
  v_mov_b32 v84, v100
  v_mov_b32 v4, v8
  v_mov_b32 v5, v9
  v_mov_b32 v6, v10
  v_mov_b32 v7, v11
sequential_preLN__mha_block__dense_activation_squared_relu__prompt_kernel_khj_71:
  s_waitcnt lgkmcnt(0)
  s_barrier
  ds_read_b128 v[36:39], v2
  ds_read_b128 v[40:43], v2 offset:1024
  ds_read_b32 v44, v112 offset:2048
  s_waitcnt lgkmcnt(0)
  v_add_f32 v76, v76, v36
  v_add_f32 v77, v77, v37
  v_add_f32 v78, v78, v38
  v_add_f32 v79, v79, v39
  v_add_f32 v80, v80, v40
  v_add_f32 v81, v81, v41
  v_add_f32 v82, v82, v42
  v_add_f32 v83, v83, v43
  v_add_f32 v84, v84, v44
  s_mov_b32 s54, 0x21800000
  s_mov_b32 s55, 0x5d800000
  v_cmp_le_f32 vcc, s54, v84
  v_cmp_ge_f32 s[56:57], s55, v84
  s_nop 3
  s_and_b64 s[56:57], s[56:57], vcc
  s_cmp_eq_u64 s[56:57], -1
  s_cbranch_scc0 sequential_preLN__mha_block__dense_activation_squared_relu__prompt_kernel_B_slow
sequential_preLN__mha_block__dense_activation_squared_relu__prompt_kernel_B_fin:
  v_rcp_f32 v110, v84
  s_nop 0
  v_mul_f32 v76, v110, v76
  v_mul_f32 v77, v110, v77
  v_mul_f32 v78, v110, v78
  v_mul_f32 v79, v110, v79
  v_mul_f32 v80, v110, v80
  v_mul_f32 v81, v110, v81
  v_mul_f32 v82, v110, v82
  v_mul_f32 v83, v110, v83
  v_cvt_pk_bf16_f32 v68, v76, v77
  v_cvt_pk_bf16_f32 v69, v78, v79
  v_cvt_pk_bf16_f32 v70, v80, v81
  v_cvt_pk_bf16_f32 v71, v82, v83
  s_lshl_b32 s54, s47, 3
  s_lshl_b32 s55, s48, 1
  s_add_u32 s54, s54, s55
  s_add_u32 s54, s54, s49
  s_lshl_b32 s54, s54, 5
  s_add_u32 s54, s54, s46
  s_lshl_b32 s54, s54, 10
  s_add_u32 s54, s54, 6291456
  buffer_store_dwordx4 v[68:71], v1, s[8:11], s54 offen sc1
  s_branch sequential_preLN__mha_block__dense_activation_squared_relu__prompt_kernel_B_done
sequential_preLN__mha_block__dense_activation_squared_relu__prompt_kernel_B_slow:
  v_mov_b32 v108, v1
  v_lshrrev_b32 v2, 5, v0
  v_and_b32 v3, 15, v0
  v_lshlrev_b32 v3, 4, v3
  v_lshl_add_u32 v3, v2, 8, v3
  v_add_u32 v109, 65536, v3
  v_mov_b32 v76, 0
  v_mov_b32 v77, 0
  v_mov_b32 v78, 0
  v_mov_b32 v79, 0
  v_mov_b32 v80, 0
  v_mov_b32 v81, 0
  v_mov_b32 v82, 0
  v_mov_b32 v83, 0
  v_mov_b32 v84, 0
  v_mov_b32 v85, 0
  v_mov_b32 v86, 0
  v_mov_b32 v87, 0
  v_mov_b32 v88, 0
  v_mov_b32 v89, 0
  v_mov_b32 v90, 0
  v_mov_b32 v91, 0
  v_mov_b32 v111, 0xff800000
  s_mov_b32 s62, 64
sequential_preLN__mha_block__dense_activation_squared_relu__prompt_kernel_B_sloop:
  ds_read_b128 v[12:15], v108 offset:0
  s_mov_b64 exec, s[60:61]
  ds_read_b128 v[20:23], v109 offset:0
  ds_read_b128 v[24:27], v109 offset:512
  s_mov_b64 exec, -1
  s_waitcnt lgkmcnt(0)
  v_mfma_f32_32x32x16_bf16 v[36:51], v[12:15], v[4:7], 0
  s_nop 15
  s_nop 3
  v_max3_f32 v113, v36, v37, v111
  v_max3_f32 v113, v38, v39, v113
  v_max3_f32 v113, v40, v41, v113
  v_max3_f32 v113, v42, v43, v113
  v_max3_f32 v113, v44, v45, v113
  v_max3_f32 v113, v46, v47, v113
  v_max3_f32 v113, v48, v49, v113
  v_max3_f32 v113, v50, v51, v113
  v_mov_b32 v114, v113
  s_nop 1
  v_permlane32_swap_b32 v113, v114
  s_nop 1
  v_max_f32 v113, v113, v114
  v_sub_f32 v112, v111, v113
  v_exp_f32 v112, v112
  v_mov_b32 v111, v113
  v_sub_f32 v36, v36, v111
  v_sub_f32 v37, v37, v111
  v_sub_f32 v38, v38, v111
  v_sub_f32 v39, v39, v111
  v_sub_f32 v40, v40, v111
  v_sub_f32 v41, v41, v111
  v_sub_f32 v42, v42, v111
  v_sub_f32 v43, v43, v111
  v_sub_f32 v44, v44, v111
  v_sub_f32 v45, v45, v111
  v_sub_f32 v46, v46, v111
  v_sub_f32 v47, v47, v111
  v_sub_f32 v48, v48, v111
  v_sub_f32 v49, v49, v111
  v_sub_f32 v50, v50, v111
  v_sub_f32 v51, v51, v111
  v_exp_f32 v36, v36
  v_exp_f32 v37, v37
  v_exp_f32 v38, v38
  v_exp_f32 v39, v39
  v_exp_f32 v40, v40
  v_exp_f32 v41, v41
  v_exp_f32 v42, v42
  v_exp_f32 v43, v43
  v_exp_f32 v44, v44
  v_exp_f32 v45, v45
  v_exp_f32 v46, v46
  v_exp_f32 v47, v47
  v_exp_f32 v48, v48
  v_exp_f32 v49, v49
  v_exp_f32 v50, v50
  v_exp_f32 v51, v51
  v_mul_f32 v76, v112, v76
  v_mul_f32 v77, v112, v77
  v_mul_f32 v78, v112, v78
  v_mul_f32 v79, v112, v79
  v_mul_f32 v80, v112, v80
  v_mul_f32 v81, v112, v81
  v_mul_f32 v82, v112, v82
  v_mul_f32 v83, v112, v83
  v_mul_f32 v84, v112, v84
  v_cvt_pk_bf16_f32 v68, v36, v37
  v_cvt_pk_bf16_f32 v69, v38, v39
  v_cvt_pk_bf16_f32 v70, v40, v41
  v_cvt_pk_bf16_f32 v71, v42, v43
  v_cvt_pk_bf16_f32 v72, v44, v45
  v_cvt_pk_bf16_f32 v73, v46, v47
  v_cvt_pk_bf16_f32 v74, v48, v49
  v_cvt_pk_bf16_f32 v75, v50, v51
  s_nop 1
  v_mfma_f32_32x32x16_bf16 v[76:91], v[20:23], v[68:71], v[76:91]
  v_mfma_f32_32x32x16_bf16 v[76:91], v[24:27], v[72:75], v[76:91]
  v_add_u32 v108, 1024, v108
  v_add_u32 v109, 1024, v109
  s_nop 15
  s_nop 3
  s_sub_u32 s62, s62, 1
  s_cmp_lg_u32 s62, 0
  s_cbranch_scc1 sequential_preLN__mha_block__dense_activation_squared_relu__prompt_kernel_B_sloop
  s_branch sequential_preLN__mha_block__dense_activation_squared_relu__prompt_kernel_B_fin
sequential_preLN__mha_block__dense_activation_squared_relu__prompt_kernel_B_done:
  s_waitcnt vmcnt(0)
  s_barrier
  s_cmp_lg_u32 s3, 0
  s_cbranch_scc1 sequential_preLN__mha_block__dense_activation_squared_relu__prompt_kernel_nw0_72
  s_lshl_b32 s52, s47, 5
  s_add_u32 s52, s52, s46
  s_lshl_b32 s52, s52, 7
  s_add_u32 s52, s52, 23101440
  v_mov_b32 v2, 0
  v_mov_b32 v3, s4
  s_mov_b64 exec, 1
  buffer_store_dword v3, v2, s[8:11], s52 offen sc1
  s_mov_b64 exec, -1
sequential_preLN__mha_block__dense_activation_squared_relu__prompt_kernel_nw0_72:
  s_and_b32 s62, s2, 7
  s_lshr_b32 s63, s2, 3
  s_lshl_b32 s55, s62, 1
  s_and_b32 s62, s63, 1
  s_add_u32 s55, s55, s62
  s_lshr_b32 s56, s63, 1
  s_mul_i32 s57, s56, 3
  s_lshl_b32 s62, s56, 1
  s_add_u32 s62, s62, 11
  s_cmp_lt_u32 s56, 11
  s_cselect_b32 s57, s57, s62
  s_cselect_b32 s59, 3, 2
  s_cmp_eq_u32 s3, 0
  s_cbranch_scc1 sequential_preLN__mha_block__dense_activation_squared_relu__prompt_kernel_w1d_73
  s_sub_u32 s62, s3, 1
  s_lshl_b32 s62, s62, 10
  s_lshl_b32 s63, s57, 15
  s_add_u32 s63, s63, 18874368
  s_add_u32 s63, s63, s62
  s_add_u32 s62, s62, 65536
  s_add_u32 m0, s62, 0
  s_add_u32 s52, s63, 0
  buffer_load_dwordx4 v1, s[8:11], s52 offen sc1 lds
  s_add_u32 m0, s62, 7168
  s_add_u32 s52, s63, 7168
  buffer_load_dwordx4 v1, s[8:11], s52 offen sc1 lds
  s_add_u32 m0, s62, 14336
  s_add_u32 s52, s63, 14336
  buffer_load_dwordx4 v1, s[8:11], s52 offen sc1 lds
  s_add_u32 m0, s62, 21504
  s_add_u32 s52, s63, 21504
  buffer_load_dwordx4 v1, s[8:11], s52 offen sc1 lds
  s_add_u32 m0, s62, 28672
  s_add_u32 s52, s63, 28672
  buffer_load_dwordx4 v1, s[8:11], s52 offen sc1 lds
  s_add_u32 m0, s62, 35840
  s_add_u32 s52, s63, 35840
  buffer_load_dwordx4 v1, s[8:11], s52 offen sc1 lds
  s_add_u32 m0, s62, 43008
  s_add_u32 s52, s63, 43008
  buffer_load_dwordx4 v1, s[8:11], s52 offen sc1 lds
  s_add_u32 m0, s62, 50176
  s_add_u32 s52, s63, 50176
  buffer_load_dwordx4 v1, s[8:11], s52 offen sc1 lds
  s_add_u32 m0, s62, 57344
  s_add_u32 s52, s63, 57344
  buffer_load_dwordx4 v1, s[8:11], s52 offen sc1 lds
  s_add_u32 m0, s62, 64512
  s_add_u32 s52, s63, 64512
  buffer_load_dwordx4 v1, s[8:11], s52 offen sc1 lds
  s_add_u32 m0, s62, 71680
  s_add_u32 s52, s63, 71680
  buffer_load_dwordx4 v1, s[8:11], s52 offen sc1 lds
  s_add_u32 m0, s62, 78848
  s_add_u32 s52, s63, 78848
  buffer_load_dwordx4 v1, s[8:11], s52 offen sc1 lds
  s_add_u32 m0, s62, 86016
  s_add_u32 s52, s63, 86016
  buffer_load_dwordx4 v1, s[8:11], s52 offen sc1 lds
  s_cmp_ge_u32 s3, 6
  s_cbranch_scc1 sequential_preLN__mha_block__dense_activation_squared_relu__prompt_kernel_w1s_74
  s_add_u32 m0, s62, 93184
  s_add_u32 s52, s63, 93184
  buffer_load_dwordx4 v1, s[8:11], s52 offen sc1 lds
sequential_preLN__mha_block__dense_activation_squared_relu__prompt_kernel_w1s_74:
sequential_preLN__mha_block__dense_activation_squared_relu__prompt_kernel_w1d_73:
  s_lshl_b32 s52, s5, 1
  s_add_u32 s52, s52, s7
  s_lshl_b32 s52, s52, 5
  s_lshl_b32 s53, s98, 4
  s_add_u32 s52, s52, s53
  s_add_u32 s52, s52, s99
  s_lshl_b32 s52, s52, 10
  s_add_u32 s52, s52, 6291456
  s_lshl_b32 s53, s7, 1
  s_add_u32 s53, s53, s98
  s_lshl_b32 s53, s53, 4
  s_add_u32 s53, s53, s99
  s_lshl_b32 s53, s53, 10
  v_mov_b32 v16, 0
  v_mov_b32 v17, 0
  v_mov_b32 v18, 0
  v_mov_b32 v19, 0
  v_mov_b32 v20, 0
  v_mov_b32 v21, 0
  v_mov_b32 v22, 0
  v_mov_b32 v23, 0
  v_mov_b32 v24, 0
  v_mov_b32 v25, 0
  v_mov_b32 v26, 0
  v_mov_b32 v27, 0
  v_mov_b32 v28, 0
  v_mov_b32 v29, 0
  v_mov_b32 v30, 0
  v_mov_b32 v31, 0
  s_lshl_b32 s54, s7, 1
  s_add_u32 s54, s54, s99
  s_lshl_b32 s54, s54, 14
  v_add_u32 v2, s54, v1
  s_cmp_lg_u32 s3, 0
  s_cbranch_scc1 sequential_preLN__mha_block__dense_activation_squared_relu__prompt_kernel_nw0_75
  s_lshr_b32 s51, s5, 2
  s_lshl_b32 s51, s51, 12
  s_add_u32 s51, s51, 23101440
  v_lshlrev_b32 v80, 7, v0
  s_mov_b32 exec_lo, 0xffffffff
  s_mov_b32 exec_hi, 0x0
  s_mov_b32 s58, 0
sequential_preLN__mha_block__dense_activation_squared_relu__prompt_kernel_poll_76:
  buffer_load_dword v81, v80, s[8:11], s51 offen sc1
sequential_preLN__mha_block__dense_activation_squared_relu__prompt_kernel_pchk_78:
  s_add_u32 s58, s58, 1
  s_waitcnt vmcnt(0)
  v_cmp_eq_u32 vcc, s4, v81
  s_cmp_gt_u32 s58, 200000
  s_cbranch_scc1 sequential_preLN__mha_block__dense_activation_squared_relu__prompt_kernel_pdone_77
  s_cmp_eq_u64 vcc, exec
  s_cbranch_scc0 sequential_preLN__mha_block__dense_activation_squared_relu__prompt_kernel_poll_76
sequential_preLN__mha_block__dense_activation_squared_relu__prompt_kernel_pdone_77:
  s_mov_b64 exec, -1
sequential_preLN__mha_block__dense_activation_squared_relu__prompt_kernel_nw0_75:
  s_barrier
  s_add_u32 m0, s53, 0
  s_add_u32 s54, s52, 0
  buffer_load_dwordx4 v1, s[8:11], s54 offen sc1 lds
  s_add_u32 m0, s53, 2048
  s_add_u32 s54, s52, 2048
  buffer_load_dwordx4 v1, s[8:11], s54 offen sc1 lds
  s_barrier
  s_add_u32 m0, s53, 4096
  s_add_u32 s54, s52, 4096
  buffer_load_dwordx4 v1, s[8:11], s54 offen sc1 lds
  s_add_u32 m0, s53, 6144
  s_add_u32 s54, s52, 6144
  buffer_load_dwordx4 v1, s[8:11], s54 offen sc1 lds
  s_barrier
  s_add_u32 m0, s53, 8192
  s_add_u32 s54, s52, 8192
  buffer_load_dwordx4 v1, s[8:11], s54 offen sc1 lds
  s_add_u32 m0, s53, 10240
  s_add_u32 s54, s52, 10240
  buffer_load_dwordx4 v1, s[8:11], s54 offen sc1 lds
  s_waitcnt vmcnt(4)
  s_barrier
  ds_read_b128 v[32:35], v2 offset:0
  ds_read_b128 v[36:39], v2 offset:1024
  ds_read_b128 v[40:43], v2 offset:2048
  ds_read_b128 v[44:47], v2 offset:3072
  s_add_u32 m0, s53, 12288
  s_add_u32 s54, s52, 12288
  buffer_load_dwordx4 v1, s[8:11], s54 offen sc1 lds
  s_add_u32 m0, s53, 14336
  s_add_u32 s54, s52, 14336
  buffer_load_dwordx4 v1, s[8:11], s54 offen sc1 lds
  s_lshl_b32 s54, s101, 5
  s_add_u32 s54, s54, s100
  s_lshl_b32 s54, s54, 10
  s_add_u32 s54, s54, 24117248
  buffer_load_dwordx4 v[4:7], v1, s[8:11], s54 offen sc1
  s_waitcnt lgkmcnt(0)
  v_mfma_f32_32x32x16_bf16 v[16:31], v[192:195], v[32:35], v[16:31]
  s_waitcnt vmcnt(5)
  s_barrier
  ds_read_b128 v[48:51], v2 offset:4096
  ds_read_b128 v[52:55], v2 offset:5120
  v_mfma_f32_32x32x16_bf16 v[16:31], v[196:199], v[36:39], v[16:31]
  ds_read_b128 v[56:59], v2 offset:6144
  ds_read_b128 v[60:63], v2 offset:7168
  v_mfma_f32_32x32x16_bf16 v[16:31], v[200:203], v[40:43], v[16:31]
  v_mfma_f32_32x32x16_bf16 v[16:31], v[204:207], v[44:47], v[16:31]
  s_waitcnt lgkmcnt(0)
  v_mfma_f32_32x32x16_bf16 v[16:31], v[208:211], v[48:51], v[16:31]
  s_waitcnt vmcnt(3)
  s_barrier
  ds_read_b128 v[32:35], v2 offset:8192
  ds_read_b128 v[36:39], v2 offset:9216
  v_mfma_f32_32x32x16_bf16 v[16:31], v[212:215], v[52:55], v[16:31]
  ds_read_b128 v[40:43], v2 offset:10240
  ds_read_b128 v[44:47], v2 offset:11264
  v_mfma_f32_32x32x16_bf16 v[16:31], v[216:219], v[56:59], v[16:31]
  v_mfma_f32_32x32x16_bf16 v[16:31], v[220:223], v[60:63], v[16:31]
  s_waitcnt lgkmcnt(0)
  v_mfma_f32_32x32x16_bf16 v[16:31], v[224:227], v[32:35], v[16:31]
  s_waitcnt vmcnt(1)
  s_barrier
  ds_read_b128 v[48:51], v2 offset:12288
  ds_read_b128 v[52:55], v2 offset:13312
  v_mfma_f32_32x32x16_bf16 v[16:31], v[228:231], v[36:39], v[16:31]
  ds_read_b128 v[56:59], v2 offset:14336
  ds_read_b128 v[60:63], v2 offset:15360
  v_mfma_f32_32x32x16_bf16 v[16:31], v[232:235], v[40:43], v[16:31]
  v_mfma_f32_32x32x16_bf16 v[16:31], v[236:239], v[44:47], v[16:31]
  s_waitcnt lgkmcnt(0)
  v_mfma_f32_32x32x16_bf16 v[16:31], v[240:243], v[48:51], v[16:31]
  v_mfma_f32_32x32x16_bf16 v[16:31], v[244:247], v[52:55], v[16:31]
  v_mfma_f32_32x32x16_bf16 v[16:31], v[248:251], v[56:59], v[16:31]
  v_mfma_f32_32x32x16_bf16 v[16:31], v[252:255], v[60:63], v[16:31]
  s_nop 15
  s_nop 3
  s_lshr_b32 s52, s3, 1
  s_lshl_b32 s52, s52, 14
  s_and_b32 s53, s3, 1
  s_lshl_b32 s53, s53, 11
  s_add_u32 s52, s52, s53
  v_add_u32 v2, s52, v1
  s_xor_b32 s52, s52, 32768
  v_add_u32 v3, s52, v1
  s_cmp_eq_u32 s99, 0
  s_cbranch_scc0 sequential_preLN__mha_block__dense_activation_squared_relu__prompt_kernel_ck_79
  ds_write_b128 v2, v[24:27]
  ds_write_b128 v2, v[28:31] offset:1024
  s_branch sequential_preLN__mha_block__dense_activation_squared_relu__prompt_kernel_cj_80
sequential_preLN__mha_block__dense_activation_squared_relu__prompt_kernel_ck_79:
  ds_write_b128 v2, v[16:19]
  ds_write_b128 v2, v[20:23] offset:1024
  v_mov_b32 v16, v24
  v_mov_b32 v17, v25
  v_mov_b32 v18, v26
  v_mov_b32 v19, v27
  v_mov_b32 v20, v28
  v_mov_b32 v21, v29
  v_mov_b32 v22, v30
  v_mov_b32 v23, v31
sequential_preLN__mha_block__dense_activation_squared_relu__prompt_kernel_cj_80:
  s_waitcnt lgkmcnt(0)
  s_barrier
  ds_read_b128 v[32:35], v3
  ds_read_b128 v[36:39], v3 offset:1024
  s_waitcnt lgkmcnt(0)
  v_add_f32 v16, v16, v32
  v_add_f32 v17, v17, v33
  v_add_f32 v18, v18, v34
  v_add_f32 v19, v19, v35
  v_add_f32 v20, v20, v36
  v_add_f32 v21, v21, v37
  v_add_f32 v22, v22, v38
  v_add_f32 v23, v23, v39
  s_waitcnt vmcnt(0)
  v_lshlrev_b32 v40, 16, v4
  v_and_b32 v41, 0xffff0000, v4
  v_add_f32 v16, v16, v40
  v_add_f32 v17, v17, v41
  v_lshlrev_b32 v40, 16, v5
  v_and_b32 v41, 0xffff0000, v5
  v_add_f32 v18, v18, v40
  v_add_f32 v19, v19, v41
  v_lshlrev_b32 v40, 16, v6
  v_and_b32 v41, 0xffff0000, v6
  v_add_f32 v20, v20, v40
  v_add_f32 v21, v21, v41
  v_lshlrev_b32 v40, 16, v7
  v_and_b32 v41, 0xffff0000, v7
  v_add_f32 v22, v22, v40
  v_add_f32 v23, v23, v41
  v_cvt_pk_bf16_f32 v44, v16, v17
  v_cvt_pk_bf16_f32 v45, v18, v19
  v_cvt_pk_bf16_f32 v46, v20, v21
  v_cvt_pk_bf16_f32 v47, v22, v23
  s_lshl_b32 s52, s101, 5
  s_add_u32 s52, s52, s100
  s_lshl_b32 s53, s52, 10
  s_add_u32 s53, s53, 8388608
  buffer_store_dwordx4 v[44:47], v1, s[8:11], s53 offen sc1
  v_mov_b32 v48, 0
  v_mov_b32 v49, 0
  v_lshlrev_b32 v50, 16, v44
  v_and_b32 v51, 0xffff0000, v44
  v_add_f32 v48, v48, v50
  v_fma_f32 v49, v50, v50, v49
  v_add_f32 v48, v48, v51
  v_fma_f32 v49, v51, v51, v49
  v_lshlrev_b32 v50, 16, v45
  v_and_b32 v51, 0xffff0000, v45
  v_add_f32 v48, v48, v50
  v_fma_f32 v49, v50, v50, v49
  v_add_f32 v48, v48, v51
  v_fma_f32 v49, v51, v51, v49
  v_lshlrev_b32 v50, 16, v46
  v_and_b32 v51, 0xffff0000, v46
  v_add_f32 v48, v48, v50
  v_fma_f32 v49, v50, v50, v49
  v_add_f32 v48, v48, v51
  v_fma_f32 v49, v51, v51, v49
  v_lshlrev_b32 v50, 16, v47
  v_and_b32 v51, 0xffff0000, v47
  v_add_f32 v48, v48, v50
  v_fma_f32 v49, v50, v50, v49
  v_add_f32 v48, v48, v51
  v_fma_f32 v49, v51, v51, v49
  v_mov_b32 v50, v48
  v_mov_b32 v51, v49
  s_nop 1
  v_permlane32_swap_b32 v48, v50
  v_permlane32_swap_b32 v49, v51
  s_nop 1
  v_add_f32 v48, v48, v50
  v_add_f32 v49, v49, v51
  v_and_b32 v12, 31, v0
  v_lshlrev_b32 v12, 3, v12
  s_lshl_b32 s53, s52, 8
  s_add_u32 s53, s53, 10485760
  s_mov_b32 exec_hi, 0
  buffer_store_dwordx2 v[48:49], v12, s[8:11], s53 offen sc1
  s_mov_b64 exec, -1
  s_waitcnt vmcnt(0)
  s_barrier
  s_cmp_lg_u32 s3, 0
  s_cbranch_scc1 sequential_preLN__mha_block__dense_activation_squared_relu__prompt_kernel_nw0_81
  s_lshr_b32 s46, s5, 1
  s_lshl_b32 s46, s46, 4
  s_and_b32 s47, s5, 1
  s_lshl_b32 s47, s47, 3
  s_add_u32 s46, s46, s47
  s_add_u32 s46, s46, s6
  s_lshl_b32 s46, s46, 7
  s_add_u32 s46, s46, 23134208
  v_mov_b32 v2, 0
  v_mov_b32 v3, s4
  s_mov_b64 exec, 1
  buffer_store_dword v3, v2, s[8:11], s46 offen sc1
  s_mov_b64 exec, -1
sequential_preLN__mha_block__dense_activation_squared_relu__prompt_kernel_nw0_81:
  s_mov_b32 s20, s34
  s_and_b32 s21, s35, 0xffff
  s_mov_b32 s22, 2752
  s_mov_b32 s23, 0x20000
  v_lshlrev_b32 v4, 2, v0
  s_lshl_b32 s52, s57, 6
  buffer_load_dword v5, v4, s[20:23], s52 offen
  s_lshl_b32 s52, s3, 12
  s_add_u32 s52, s52, 65536
  v_add_u32 v2, s52, v1
  v_add_u32 v3, 65536, v2
  ds_read_b128 v[16:19], v2 offset:0
  ds_read_b128 v[20:23], v2 offset:1024
  ds_read_b128 v[24:27], v2 offset:2048
  ds_read_b128 v[28:31], v2 offset:3072
  ds_read_b128 v[32:35], v2 offset:32768
  ds_read_b128 v[36:39], v2 offset:33792
  ds_read_b128 v[40:43], v2 offset:34816
  ds_read_b128 v[44:47], v2 offset:35840
  ds_read_b128 v[48:51], v3 offset:0
  ds_read_b128 v[52:55], v3 offset:1024
  ds_read_b128 v[56:59], v3 offset:2048
  ds_read_b128 v[60:63], v3 offset:3072
  v_mov_b32 v6, 0x3f803f80
  v_mov_b32 v64, 0
  v_mov_b32 v65, 0
  v_mov_b32 v66, 0
  v_mov_b32 v67, 0
  v_mov_b32 v68, 0
  v_mov_b32 v69, 0
  v_mov_b32 v70, 0
  v_mov_b32 v71, 0
  v_mov_b32 v72, 0
  v_mov_b32 v73, 0
  v_mov_b32 v74, 0
  v_mov_b32 v75, 0
  v_and_b32 v14, 31, v0
  v_lshlrev_b32 v14, 2, v14
  s_mul_i32 s52, s3, 384
  s_add_u32 s52, s52, 49152
  v_add_u32 v15, s52, v14
  s_waitcnt lgkmcnt(8)
  v_dot2_f32_bf16 v64, v16, v6, v64
  v_dot2_f32_bf16 v65, v17, v6, v65
  v_dot2_f32_bf16 v66, v18, v6, v66
  v_dot2_f32_bf16 v67, v19, v6, v67
  v_dot2_f32_bf16 v64, v20, v6, v64
  v_dot2_f32_bf16 v65, v21, v6, v65
  v_dot2_f32_bf16 v66, v22, v6, v66
  v_dot2_f32_bf16 v67, v23, v6, v67
  v_dot2_f32_bf16 v64, v24, v6, v64
  v_dot2_f32_bf16 v65, v25, v6, v65
  v_dot2_f32_bf16 v66, v26, v6, v66
  v_dot2_f32_bf16 v67, v27, v6, v67
  v_dot2_f32_bf16 v64, v28, v6, v64
  v_dot2_f32_bf16 v65, v29, v6, v65
  v_dot2_f32_bf16 v66, v30, v6, v66
  v_dot2_f32_bf16 v67, v31, v6, v67
  s_waitcnt lgkmcnt(4)
  v_dot2_f32_bf16 v68, v32, v6, v68
  v_dot2_f32_bf16 v69, v33, v6, v69
  v_dot2_f32_bf16 v70, v34, v6, v70
  v_dot2_f32_bf16 v71, v35, v6, v71
  v_dot2_f32_bf16 v68, v36, v6, v68
  v_dot2_f32_bf16 v69, v37, v6, v69
  v_dot2_f32_bf16 v70, v38, v6, v70
  v_dot2_f32_bf16 v71, v39, v6, v71
  v_dot2_f32_bf16 v68, v40, v6, v68
  v_dot2_f32_bf16 v69, v41, v6, v69
  v_dot2_f32_bf16 v70, v42, v6, v70
  v_dot2_f32_bf16 v71, v43, v6, v71
  v_dot2_f32_bf16 v68, v44, v6, v68
  v_dot2_f32_bf16 v69, v45, v6, v69
  v_dot2_f32_bf16 v70, v46, v6, v70
  v_dot2_f32_bf16 v71, v47, v6, v71
  s_waitcnt lgkmcnt(0)
  v_dot2_f32_bf16 v72, v48, v6, v72
  v_dot2_f32_bf16 v73, v49, v6, v73
  v_dot2_f32_bf16 v74, v50, v6, v74
  v_dot2_f32_bf16 v75, v51, v6, v75
  v_dot2_f32_bf16 v72, v52, v6, v72
  v_dot2_f32_bf16 v73, v53, v6, v73
  v_dot2_f32_bf16 v74, v54, v6, v74
  v_dot2_f32_bf16 v75, v55, v6, v75
  v_dot2_f32_bf16 v72, v56, v6, v72
  v_dot2_f32_bf16 v73, v57, v6, v73
  v_dot2_f32_bf16 v74, v58, v6, v74
  v_dot2_f32_bf16 v75, v59, v6, v75
  v_dot2_f32_bf16 v72, v60, v6, v72
  v_dot2_f32_bf16 v73, v61, v6, v73
  v_dot2_f32_bf16 v74, v62, v6, v74
  v_dot2_f32_bf16 v75, v63, v6, v75
  s_cmp_lg_u32 s3, 0
  s_cbranch_scc1 sequential_preLN__mha_block__dense_activation_squared_relu__prompt_kernel_nw0_82
  s_lshl_b32 s51, s55, 11
  s_add_u32 s51, s51, 23134208
  v_lshlrev_b32 v80, 7, v0
  s_mov_b32 exec_lo, 0xffff
  s_mov_b32 exec_hi, 0x0
  buffer_load_dword v81, v80, s[8:11], s51 offen sc1
  s_mov_b64 exec, -1
sequential_preLN__mha_block__dense_activation_squared_relu__prompt_kernel_nw0_82:
  s_nop 2
  v_add_f32 v64, v64, v65
  v_add_f32 v66, v66, v67
  v_add_f32 v68, v68, v69
  v_add_f32 v70, v70, v71
  v_add_f32 v72, v72, v73
  v_add_f32 v74, v74, v75
  v_add_f32 v64, v64, v66
  v_mov_b32 v65, v64
  v_add_f32 v68, v68, v70
  v_mov_b32 v69, v68
  v_add_f32 v72, v72, v74
  v_mov_b32 v73, v72
  s_nop 1
  v_permlane32_swap_b32 v64, v65
  v_permlane32_swap_b32 v68, v69
  v_permlane32_swap_b32 v72, v73
  s_nop 1
  v_add_f32 v64, v64, v65
  v_add_f32 v68, v68, v69
  v_add_f32 v72, v72, v73
  ds_write_b32 v15, v64 offset:0
  ds_write_b32 v15, v68 offset:128
  ds_write_b32 v15, v72 offset:256
  s_cmp_eq_u32 s3, 7
  s_cbranch_scc0 sequential_preLN__mha_block__dense_activation_squared_relu__prompt_kernel_b1w_83
  s_waitcnt vmcnt(0)
  v_lshlrev_b32 v6, 16, v5
  v_and_b32 v7, 0xffff0000, v5
  v_lshlrev_b32 v4, 3, v0
  v_add_u32 v4, 52608, v4
  s_mov_b32 exec_hi, 0xffff
  ds_write_b64 v4, v[6:7]
  s_mov_b64 exec, -1
sequential_preLN__mha_block__dense_activation_squared_relu__prompt_kernel_b1w_83:
  s_cmp_eq_u32 s3, 0
  s_cbranch_scc1 sequential_preLN__mha_block__dense_activation_squared_relu__prompt_kernel_w2l_84
  s_and_b32 s62, s3, 1
  s_lshr_b32 s63, s3, 1
  s_lshl_b32 s54, s6, 1
  s_add_u32 s54, s54, s62
  s_mul_i32 s54, s54, 86
  s_mul_i32 s62, s63, 22
  s_add_u32 s54, s54, s62
  s_lshl_b32 s54, s54, 10
  s_add_u32 s54, s54, 20971520
  s_add_u32 s54, s54, 12288
  s_add_u32 s54, s54, 4096
  buffer_load_dwordx4 v[192:195], v1, s[8:11], s54 offen offset:0 sc1
  buffer_load_dwordx4 v[196:199], v1, s[8:11], s54 offen offset:1024 sc1
  buffer_load_dwordx4 v[200:203], v1, s[8:11], s54 offen offset:2048 sc1
  buffer_load_dwordx4 v[204:207], v1, s[8:11], s54 offen offset:3072 sc1
  s_add_u32 s54, s54, 4096
  buffer_load_dwordx4 v[208:211], v1, s[8:11], s54 offen offset:0 sc1
  buffer_load_dwordx4 v[212:215], v1, s[8:11], s54 offen offset:1024 sc1
sequential_preLN__mha_block__dense_activation_squared_relu__prompt_kernel_w2l_84:
  s_waitcnt lgkmcnt(0)
  s_barrier
  s_sub_u32 s52, s3, 1
  s_cmp_ge_u32 s52, 3
  s_cbranch_scc1 sequential_preLN__mha_block__dense_activation_squared_relu__prompt_kernel_csf_85
  s_lshl_b32 s52, s52, 7
  s_add_u32 s53, s52, 49152
  v_add_u32 v15, s53, v14
  ds_read_b32 v16, v15 offset:0
  ds_read_b32 v17, v15 offset:384
  ds_read_b32 v18, v15 offset:768
  ds_read_b32 v19, v15 offset:1152
  ds_read_b32 v20, v15 offset:1536
  ds_read_b32 v21, v15 offset:1920
  ds_read_b32 v22, v15 offset:2304
  ds_read_b32 v23, v15 offset:2688
  s_waitcnt lgkmcnt(0)
  v_add_f32 v16, v16, v20
  v_add_f32 v17, v17, v21
  v_add_f32 v18, v18, v22
  v_add_f32 v19, v19, v23
  v_add_f32 v16, v16, v17
  v_add_f32 v18, v18, v19
  v_add_f32 v16, v16, v18
  s_add_u32 s53, s52, 52224
  v_add_u32 v15, s53, v14
  ds_write_b32 v15, v16
  s_waitcnt lgkmcnt(0)
sequential_preLN__mha_block__dense_activation_squared_relu__prompt_kernel_csf_85:
  s_and_b32 s46, s3, 3
  s_lshr_b32 s48, s3, 2
  s_lshl_b32 s47, s55, 2
  s_add_u32 s47, s47, s46
  s_lshl_b32 s49, s47, 5
  s_lshl_b32 s52, s48, 4
  s_add_u32 s49, s49, s52
  s_lshl_b32 s49, s49, 10
  s_add_u32 s49, s49, 8388608
  v_mov_b32 v16, 0
  v_mov_b32 v17, 0
  v_mov_b32 v18, 0
  v_mov_b32 v19, 0
  v_mov_b32 v20, 0
  v_mov_b32 v21, 0
  v_mov_b32 v22, 0
  v_mov_b32 v23, 0
  v_mov_b32 v24, 0
  v_mov_b32 v25, 0
  v_mov_b32 v26, 0
  v_mov_b32 v27, 0
  v_mov_b32 v28, 0
  v_mov_b32 v29, 0
  v_mov_b32 v30, 0
  v_mov_b32 v31, 0
  v_mov_b32 v32, 0
  v_mov_b32 v33, 0
  v_mov_b32 v34, 0
  v_mov_b32 v35, 0
  v_mov_b32 v36, 0
  v_mov_b32 v37, 0
  v_mov_b32 v38, 0
  v_mov_b32 v39, 0
  v_mov_b32 v40, 0
  v_mov_b32 v41, 0
  v_mov_b32 v42, 0
  v_mov_b32 v43, 0
  v_mov_b32 v44, 0
  v_mov_b32 v45, 0
  v_mov_b32 v46, 0
  v_mov_b32 v47, 0
  v_mov_b32 v48, 0
  v_mov_b32 v49, 0
  v_mov_b32 v50, 0
  v_mov_b32 v51, 0
  v_mov_b32 v52, 0
  v_mov_b32 v53, 0
  v_mov_b32 v54, 0
  v_mov_b32 v55, 0
  v_mov_b32 v56, 0
  v_mov_b32 v57, 0
  v_mov_b32 v58, 0
  v_mov_b32 v59, 0
  v_mov_b32 v60, 0
  v_mov_b32 v61, 0
  v_mov_b32 v62, 0
  v_mov_b32 v63, 0
  s_lshl_b32 s52, s48, 14
  s_add_u32 s52, s52, 65536
  v_add_u32 v3, s52, v1
  v_add_u32 v4, 65536, v3
  v_and_b32 v8, 31, v0
  v_lshrrev_b32 v9, 5, v0
  v_lshlrev_b32 v12, 3, v8
  v_lshl_add_u32 v12, v9, 12, v12
  s_lshl_b32 s53, s47, 13
  s_add_u32 s53, s53, 10485760
  ds_read_b128 v[216:219], v3 offset:0
  ds_read_b128 v[220:223], v3 offset:32768
  ds_read_b128 v[224:227], v3 offset:1024
  ds_read_b128 v[228:231], v3 offset:33792
  s_cmp_lg_u32 s3, 0
  s_cbranch_scc1 sequential_preLN__mha_block__dense_activation_squared_relu__prompt_kernel_nw0_86
  s_mov_b32 exec_lo, 0xffff
  s_mov_b32 exec_hi, 0x0
  s_mov_b32 s58, 0
  s_branch sequential_preLN__mha_block__dense_activation_squared_relu__prompt_kernel_pchk_89
sequential_preLN__mha_block__dense_activation_squared_relu__prompt_kernel_poll_87:
  buffer_load_dword v81, v80, s[8:11], s51 offen sc1
sequential_preLN__mha_block__dense_activation_squared_relu__prompt_kernel_pchk_89:
  s_add_u32 s58, s58, 1
  s_waitcnt vmcnt(0)
  v_cmp_eq_u32 vcc, s4, v81
  s_cmp_gt_u32 s58, 200000
  s_cbranch_scc1 sequential_preLN__mha_block__dense_activation_squared_relu__prompt_kernel_pdone_88
  s_cmp_eq_u64 vcc, exec
  s_cbranch_scc0 sequential_preLN__mha_block__dense_activation_squared_relu__prompt_kernel_poll_87
sequential_preLN__mha_block__dense_activation_squared_relu__prompt_kernel_pdone_88:
  s_mov_b64 exec, -1
sequential_preLN__mha_block__dense_activation_squared_relu__prompt_kernel_nw0_86:
  s_barrier
  buffer_load_dwordx4 v[64:67], v1, s[8:11], s49 offen offset:0 sc1
  buffer_load_dwordx4 v[68:71], v1, s[8:11], s49 offen offset:1024 sc1
  s_barrier
  buffer_load_dwordx4 v[72:75], v1, s[8:11], s49 offen offset:2048 sc1
  buffer_load_dwordx4 v[76:79], v1, s[8:11], s49 offen offset:3072 sc1
  s_add_u32 s49, s49, 4096
  buffer_load_dwordx4 v[80:83], v1, s[8:11], s49 offen offset:0 sc1
  s_mul_i32 s52, s3, 6144
  v_add_u32 v2, s52, v1
  s_xor_b32 s52, s3, 4
  s_mul_i32 s52, s52, 6144
  v_add_u32 v5, s52, v1
  s_cmp_eq_u32 s48, 1
  s_cbranch_scc1 sequential_preLN__mha_block__dense_activation_squared_relu__prompt_kernel_dhi_90
  s_waitcnt vmcnt(4)
  ds_read_b128 v[232:235], v3 offset:2048
  ds_read_b128 v[236:239], v3 offset:34816
  s_waitcnt lgkmcnt(4)
  v_mfma_f32_32x32x16_bf16 v[16:31], v[216:219], v[64:67], v[16:31]
  buffer_load_dwordx4 v[84:87], v1, s[8:11], s49 offen offset:1024 sc1
  v_mfma_f32_32x32x16_bf16 v[32:47], v[220:223], v[64:67], v[32:47]
  s_waitcnt vmcnt(4)
  ds_read_b128 v[216:219], v3 offset:3072
  ds_read_b128 v[220:223], v3 offset:35840
  s_waitcnt lgkmcnt(4)
  v_mfma_f32_32x32x16_bf16 v[16:31], v[224:227], v[68:71], v[16:31]
  buffer_load_dwordx4 v[88:91], v1, s[8:11], s49 offen offset:2048 sc1
  v_mfma_f32_32x32x16_bf16 v[32:47], v[228:231], v[68:71], v[32:47]
  s_waitcnt vmcnt(4)
  ds_read_b128 v[224:227], v3 offset:4096
  ds_read_b128 v[228:231], v3 offset:36864
  s_waitcnt lgkmcnt(4)
  v_mfma_f32_32x32x16_bf16 v[16:31], v[232:235], v[72:75], v[16:31]
  buffer_load_dwordx4 v[92:95], v1, s[8:11], s49 offen offset:3072 sc1
  v_mfma_f32_32x32x16_bf16 v[32:47], v[236:239], v[72:75], v[32:47]
  s_waitcnt vmcnt(4)
  ds_read_b128 v[232:235], v3 offset:5120
  ds_read_b128 v[236:239], v3 offset:37888
  s_waitcnt lgkmcnt(4)
  v_mfma_f32_32x32x16_bf16 v[16:31], v[216:219], v[76:79], v[16:31]
  s_add_u32 s49, s49, 4096
  buffer_load_dwordx4 v[96:99], v1, s[8:11], s49 offen offset:0 sc1
  v_mfma_f32_32x32x16_bf16 v[32:47], v[220:223], v[76:79], v[32:47]
  s_waitcnt vmcnt(4)
  ds_read_b128 v[216:219], v3 offset:6144
  ds_read_b128 v[220:223], v3 offset:38912
  s_waitcnt lgkmcnt(4)
  v_mfma_f32_32x32x16_bf16 v[16:31], v[224:227], v[80:83], v[16:31]
  buffer_load_dwordx4 v[100:103], v1, s[8:11], s49 offen offset:1024 sc1
  v_mfma_f32_32x32x16_bf16 v[32:47], v[228:231], v[80:83], v[32:47]
  s_waitcnt vmcnt(4)
  ds_read_b128 v[224:227], v3 offset:7168
  ds_read_b128 v[228:231], v3 offset:39936
  s_waitcnt lgkmcnt(4)
  v_mfma_f32_32x32x16_bf16 v[16:31], v[232:235], v[84:87], v[16:31]
  buffer_load_dwordx4 v[104:107], v1, s[8:11], s49 offen offset:2048 sc1
  v_mfma_f32_32x32x16_bf16 v[32:47], v[236:239], v[84:87], v[32:47]
  s_waitcnt vmcnt(4)
  ds_read_b128 v[232:235], v3 offset:8192
  ds_read_b128 v[236:239], v3 offset:40960
  s_waitcnt lgkmcnt(4)
  v_mfma_f32_32x32x16_bf16 v[16:31], v[216:219], v[88:91], v[16:31]
  buffer_load_dwordx4 v[108:111], v1, s[8:11], s49 offen offset:3072 sc1
  v_mfma_f32_32x32x16_bf16 v[32:47], v[220:223], v[88:91], v[32:47]
  s_waitcnt vmcnt(4)
  ds_read_b128 v[216:219], v3 offset:9216
  ds_read_b128 v[220:223], v3 offset:41984
  s_waitcnt lgkmcnt(4)
  v_mfma_f32_32x32x16_bf16 v[16:31], v[224:227], v[92:95], v[16:31]
  s_add_u32 s49, s49, 4096
  buffer_load_dwordx4 v[112:115], v1, s[8:11], s49 offen offset:0 sc1
  v_mfma_f32_32x32x16_bf16 v[32:47], v[228:231], v[92:95], v[32:47]
  s_waitcnt vmcnt(4)
  ds_read_b128 v[224:227], v3 offset:10240
  ds_read_b128 v[228:231], v3 offset:43008
  s_waitcnt lgkmcnt(4)
  v_mfma_f32_32x32x16_bf16 v[16:31], v[232:235], v[96:99], v[16:31]
  buffer_load_dwordx4 v[116:119], v1, s[8:11], s49 offen offset:1024 sc1
  v_mfma_f32_32x32x16_bf16 v[32:47], v[236:239], v[96:99], v[32:47]
  s_waitcnt vmcnt(4)
  ds_read_b128 v[232:235], v3 offset:11264
  ds_read_b128 v[236:239], v3 offset:44032
  s_waitcnt lgkmcnt(4)
  v_mfma_f32_32x32x16_bf16 v[16:31], v[216:219], v[100:103], v[16:31]
  buffer_load_dwordx4 v[120:123], v1, s[8:11], s49 offen offset:2048 sc1
  v_mfma_f32_32x32x16_bf16 v[32:47], v[220:223], v[100:103], v[32:47]
  s_waitcnt vmcnt(4)
  ds_read_b128 v[216:219], v3 offset:12288
  ds_read_b128 v[220:223], v3 offset:45056
  s_waitcnt lgkmcnt(4)
  v_mfma_f32_32x32x16_bf16 v[16:31], v[224:227], v[104:107], v[16:31]
  buffer_load_dwordx4 v[124:127], v1, s[8:11], s49 offen offset:3072 sc1
  v_mfma_f32_32x32x16_bf16 v[32:47], v[228:231], v[104:107], v[32:47]
  s_waitcnt vmcnt(4)
  ds_read_b128 v[224:227], v3 offset:13312
  ds_read_b128 v[228:231], v3 offset:46080
  s_waitcnt lgkmcnt(4)
  v_mfma_f32_32x32x16_bf16 v[16:31], v[232:235], v[108:111], v[16:31]
  v_mfma_f32_32x32x16_bf16 v[32:47], v[236:239], v[108:111], v[32:47]
  s_waitcnt vmcnt(3)
  ds_read_b128 v[232:235], v3 offset:14336
  ds_read_b128 v[236:239], v3 offset:47104
  s_waitcnt lgkmcnt(4)
  v_mfma_f32_32x32x16_bf16 v[16:31], v[216:219], v[112:115], v[16:31]
  v_mfma_f32_32x32x16_bf16 v[32:47], v[220:223], v[112:115], v[32:47]
  s_waitcnt vmcnt(2)
  ds_read_b128 v[216:219], v3 offset:15360
  ds_read_b128 v[220:223], v3 offset:48128
  s_waitcnt lgkmcnt(4)
  v_mfma_f32_32x32x16_bf16 v[16:31], v[224:227], v[116:119], v[16:31]
  v_mfma_f32_32x32x16_bf16 v[32:47], v[228:231], v[116:119], v[32:47]
  s_waitcnt vmcnt(1)
  s_waitcnt lgkmcnt(2)
  v_mfma_f32_32x32x16_bf16 v[16:31], v[232:235], v[120:123], v[16:31]
  v_mfma_f32_32x32x16_bf16 v[32:47], v[236:239], v[120:123], v[32:47]
  s_waitcnt vmcnt(0)
  s_waitcnt lgkmcnt(0)
  v_mfma_f32_32x32x16_bf16 v[16:31], v[216:219], v[124:127], v[16:31]
  v_mfma_f32_32x32x16_bf16 v[32:47], v[220:223], v[124:127], v[32:47]
  ds_read_b128 v[216:219], v4 offset:0
  ds_read_b128 v[220:223], v4 offset:1024
  ds_read_b128 v[224:227], v4 offset:2048
  s_cmp_lg_u32 s3, 0
  s_cbranch_scc1 sequential_preLN__mha_block__dense_activation_squared_relu__prompt_kernel_nw0_92
  s_and_b32 s62, s3, 1
  s_lshr_b32 s63, s3, 1
  s_lshl_b32 s54, s6, 1
  s_add_u32 s54, s54, s62
  s_mul_i32 s54, s54, 86
  s_mul_i32 s62, s63, 22
  s_add_u32 s54, s54, s62
  s_lshl_b32 s54, s54, 10
  s_add_u32 s54, s54, 20971520
  s_add_u32 s54, s54, 12288
  s_add_u32 s54, s54, 4096
  buffer_load_dwordx4 v[192:195], v1, s[8:11], s54 offen offset:0 sc1
  buffer_load_dwordx4 v[196:199], v1, s[8:11], s54 offen offset:1024 sc1
  buffer_load_dwordx4 v[200:203], v1, s[8:11], s54 offen offset:2048 sc1
  buffer_load_dwordx4 v[204:207], v1, s[8:11], s54 offen offset:3072 sc1
  s_add_u32 s54, s54, 4096
  buffer_load_dwordx4 v[208:211], v1, s[8:11], s54 offen offset:0 sc1
  buffer_load_dwordx4 v[212:215], v1, s[8:11], s54 offen offset:1024 sc1
sequential_preLN__mha_block__dense_activation_squared_relu__prompt_kernel_nw0_92:
  ds_read_b128 v[228:231], v4 offset:3072
  s_waitcnt lgkmcnt(3)
  v_mfma_f32_32x32x16_bf16 v[48:63], v[216:219], v[64:67], v[48:63]
  ds_read_b128 v[216:219], v4 offset:4096
  s_waitcnt lgkmcnt(3)
  v_mfma_f32_32x32x16_bf16 v[48:63], v[220:223], v[68:71], v[48:63]
  ds_read_b128 v[220:223], v4 offset:5120
  s_waitcnt lgkmcnt(3)
  v_mfma_f32_32x32x16_bf16 v[48:63], v[224:227], v[72:75], v[48:63]
  ds_read_b128 v[224:227], v4 offset:6144
  s_waitcnt lgkmcnt(3)
  v_mfma_f32_32x32x16_bf16 v[48:63], v[228:231], v[76:79], v[48:63]
  ds_write_b128 v2, v[24:27] offset:0
  ds_write_b128 v2, v[28:31] offset:1024
  ds_read_b128 v[228:231], v4 offset:7168
  s_waitcnt lgkmcnt(5)
  v_mfma_f32_32x32x16_bf16 v[48:63], v[216:219], v[80:83], v[48:63]
  ds_read_b128 v[216:219], v4 offset:8192
  s_waitcnt lgkmcnt(5)
  v_mfma_f32_32x32x16_bf16 v[48:63], v[220:223], v[84:87], v[48:63]
  ds_read_b128 v[220:223], v4 offset:9216
  s_waitcnt lgkmcnt(5)
  v_mfma_f32_32x32x16_bf16 v[48:63], v[224:227], v[88:91], v[48:63]
  ds_write_b128 v2, v[40:43] offset:2048
  ds_write_b128 v2, v[44:47] offset:3072
  ds_read_b128 v[224:227], v4 offset:10240
  s_waitcnt lgkmcnt(5)
  v_mfma_f32_32x32x16_bf16 v[48:63], v[228:231], v[92:95], v[48:63]
  ds_read_b128 v[228:231], v4 offset:11264
  s_waitcnt lgkmcnt(5)
  v_mfma_f32_32x32x16_bf16 v[48:63], v[216:219], v[96:99], v[48:63]
  ds_read_b128 v[216:219], v4 offset:12288
  s_waitcnt lgkmcnt(5)
  v_mfma_f32_32x32x16_bf16 v[48:63], v[220:223], v[100:103], v[48:63]
  ds_read_b128 v[220:223], v4 offset:13312
  s_waitcnt lgkmcnt(3)
  v_mfma_f32_32x32x16_bf16 v[48:63], v[224:227], v[104:107], v[48:63]
  ds_read_b128 v[224:227], v4 offset:14336
  s_waitcnt lgkmcnt(3)
  v_mfma_f32_32x32x16_bf16 v[48:63], v[228:231], v[108:111], v[48:63]
  ds_read_b128 v[228:231], v4 offset:15360
  s_waitcnt lgkmcnt(3)
  v_mfma_f32_32x32x16_bf16 v[48:63], v[216:219], v[112:115], v[48:63]
  s_waitcnt lgkmcnt(2)
  v_mfma_f32_32x32x16_bf16 v[48:63], v[220:223], v[116:119], v[48:63]
  s_waitcnt lgkmcnt(1)
  v_mfma_f32_32x32x16_bf16 v[48:63], v[224:227], v[120:123], v[48:63]
  s_waitcnt lgkmcnt(0)
  v_mfma_f32_32x32x16_bf16 v[48:63], v[228:231], v[124:127], v[48:63]
  s_nop 15
  ds_write_b128 v2, v[56:59] offset:4096
  ds_write_b128 v2, v[60:63] offset:5120
  s_branch sequential_preLN__mha_block__dense_activation_squared_relu__prompt_kernel_depi_91
sequential_preLN__mha_block__dense_activation_squared_relu__prompt_kernel_dhi_90:
  s_waitcnt vmcnt(4)
  ds_read_b128 v[232:235], v3 offset:2048
  ds_read_b128 v[236:239], v3 offset:34816
  s_waitcnt lgkmcnt(4)
  v_mfma_f32_32x32x16_bf16 v[16:31], v[216:219], v[64:67], v[16:31]
  buffer_load_dwordx4 v[84:87], v1, s[8:11], s49 offen offset:1024 sc1
  v_mfma_f32_32x32x16_bf16 v[32:47], v[220:223], v[64:67], v[32:47]
  s_waitcnt vmcnt(4)
  ds_read_b128 v[216:219], v3 offset:3072
  ds_read_b128 v[220:223], v3 offset:35840
  s_waitcnt lgkmcnt(4)
  v_mfma_f32_32x32x16_bf16 v[16:31], v[224:227], v[68:71], v[16:31]
  buffer_load_dwordx4 v[88:91], v1, s[8:11], s49 offen offset:2048 sc1
  v_mfma_f32_32x32x16_bf16 v[32:47], v[228:231], v[68:71], v[32:47]
  s_waitcnt vmcnt(4)
  ds_read_b128 v[224:227], v3 offset:4096
  ds_read_b128 v[228:231], v3 offset:36864
  s_waitcnt lgkmcnt(4)
  v_mfma_f32_32x32x16_bf16 v[16:31], v[232:235], v[72:75], v[16:31]
  buffer_load_dwordx4 v[92:95], v1, s[8:11], s49 offen offset:3072 sc1
  v_mfma_f32_32x32x16_bf16 v[32:47], v[236:239], v[72:75], v[32:47]
  s_waitcnt vmcnt(4)
  ds_read_b128 v[232:235], v3 offset:5120
  ds_read_b128 v[236:239], v3 offset:37888
  s_waitcnt lgkmcnt(4)
  v_mfma_f32_32x32x16_bf16 v[16:31], v[216:219], v[76:79], v[16:31]
  s_add_u32 s49, s49, 4096
  buffer_load_dwordx4 v[96:99], v1, s[8:11], s49 offen offset:0 sc1
  v_mfma_f32_32x32x16_bf16 v[32:47], v[220:223], v[76:79], v[32:47]
  s_waitcnt vmcnt(4)
  ds_read_b128 v[216:219], v3 offset:6144
  ds_read_b128 v[220:223], v3 offset:38912
  s_waitcnt lgkmcnt(4)
  v_mfma_f32_32x32x16_bf16 v[16:31], v[224:227], v[80:83], v[16:31]
  buffer_load_dwordx4 v[100:103], v1, s[8:11], s49 offen offset:1024 sc1
  v_mfma_f32_32x32x16_bf16 v[32:47], v[228:231], v[80:83], v[32:47]
  s_waitcnt vmcnt(4)
  ds_read_b128 v[224:227], v3 offset:7168
  ds_read_b128 v[228:231], v3 offset:39936
  s_waitcnt lgkmcnt(4)
  v_mfma_f32_32x32x16_bf16 v[16:31], v[232:235], v[84:87], v[16:31]
  buffer_load_dwordx4 v[104:107], v1, s[8:11], s49 offen offset:2048 sc1
  v_mfma_f32_32x32x16_bf16 v[32:47], v[236:239], v[84:87], v[32:47]
  s_waitcnt vmcnt(4)
  ds_read_b128 v[232:235], v3 offset:8192
  ds_read_b128 v[236:239], v3 offset:40960
  s_waitcnt lgkmcnt(4)
  v_mfma_f32_32x32x16_bf16 v[16:31], v[216:219], v[88:91], v[16:31]
  buffer_load_dwordx4 v[108:111], v1, s[8:11], s49 offen offset:3072 sc1
  v_mfma_f32_32x32x16_bf16 v[32:47], v[220:223], v[88:91], v[32:47]
  s_waitcnt vmcnt(4)
  ds_read_b128 v[216:219], v3 offset:9216
  ds_read_b128 v[220:223], v3 offset:41984
  s_waitcnt lgkmcnt(4)
  v_mfma_f32_32x32x16_bf16 v[16:31], v[224:227], v[92:95], v[16:31]
  s_add_u32 s49, s49, 4096
  buffer_load_dwordx4 v[112:115], v1, s[8:11], s49 offen offset:0 sc1
  v_mfma_f32_32x32x16_bf16 v[32:47], v[228:231], v[92:95], v[32:47]
  s_waitcnt vmcnt(4)
  ds_read_b128 v[224:227], v3 offset:10240
  ds_read_b128 v[228:231], v3 offset:43008
  s_waitcnt lgkmcnt(4)
  v_mfma_f32_32x32x16_bf16 v[16:31], v[232:235], v[96:99], v[16:31]
  buffer_load_dwordx4 v[116:119], v1, s[8:11], s49 offen offset:1024 sc1
  v_mfma_f32_32x32x16_bf16 v[32:47], v[236:239], v[96:99], v[32:47]
  s_waitcnt vmcnt(4)
  ds_read_b128 v[232:235], v3 offset:11264
  ds_read_b128 v[236:239], v3 offset:44032
  s_waitcnt lgkmcnt(4)
  v_mfma_f32_32x32x16_bf16 v[16:31], v[216:219], v[100:103], v[16:31]
  buffer_load_dwordx4 v[120:123], v1, s[8:11], s49 offen offset:2048 sc1
  v_mfma_f32_32x32x16_bf16 v[32:47], v[220:223], v[100:103], v[32:47]
  s_waitcnt vmcnt(4)
  ds_read_b128 v[216:219], v3 offset:12288
  ds_read_b128 v[220:223], v3 offset:45056
  s_waitcnt lgkmcnt(4)
  v_mfma_f32_32x32x16_bf16 v[16:31], v[224:227], v[104:107], v[16:31]
  buffer_load_dwordx4 v[124:127], v1, s[8:11], s49 offen offset:3072 sc1
  v_mfma_f32_32x32x16_bf16 v[32:47], v[228:231], v[104:107], v[32:47]
  s_waitcnt vmcnt(4)
  ds_read_b128 v[224:227], v3 offset:13312
  ds_read_b128 v[228:231], v3 offset:46080
  s_waitcnt lgkmcnt(4)
  v_mfma_f32_32x32x16_bf16 v[16:31], v[232:235], v[108:111], v[16:31]
  v_mfma_f32_32x32x16_bf16 v[32:47], v[236:239], v[108:111], v[32:47]
  buffer_load_dwordx2 v[240:241], v12, s[8:11], s53 offen offset:0 sc1
  buffer_load_dwordx2 v[242:243], v12, s[8:11], s53 offen offset:256 sc1
  buffer_load_dwordx2 v[244:245], v12, s[8:11], s53 offen offset:512 sc1
  buffer_load_dwordx2 v[246:247], v12, s[8:11], s53 offen offset:768 sc1
  buffer_load_dwordx2 v[248:249], v12, s[8:11], s53 offen offset:1024 sc1
  buffer_load_dwordx2 v[250:251], v12, s[8:11], s53 offen offset:1280 sc1
  buffer_load_dwordx2 v[252:253], v12, s[8:11], s53 offen offset:1536 sc1
  buffer_load_dwordx2 v[254:255], v12, s[8:11], s53 offen offset:1792 sc1
  s_waitcnt vmcnt(11)
  ds_read_b128 v[232:235], v3 offset:14336
  ds_read_b128 v[236:239], v3 offset:47104
  s_waitcnt lgkmcnt(4)
  v_mfma_f32_32x32x16_bf16 v[16:31], v[216:219], v[112:115], v[16:31]
  v_mfma_f32_32x32x16_bf16 v[32:47], v[220:223], v[112:115], v[32:47]
  s_waitcnt vmcnt(10)
  ds_read_b128 v[216:219], v3 offset:15360
  ds_read_b128 v[220:223], v3 offset:48128
  s_waitcnt lgkmcnt(4)
  v_mfma_f32_32x32x16_bf16 v[16:31], v[224:227], v[116:119], v[16:31]
  v_mfma_f32_32x32x16_bf16 v[32:47], v[228:231], v[116:119], v[32:47]
  s_waitcnt vmcnt(9)
  s_waitcnt lgkmcnt(2)
  v_mfma_f32_32x32x16_bf16 v[16:31], v[232:235], v[120:123], v[16:31]
  v_mfma_f32_32x32x16_bf16 v[32:47], v[236:239], v[120:123], v[32:47]
  s_waitcnt vmcnt(8)
  s_waitcnt lgkmcnt(0)
  v_mfma_f32_32x32x16_bf16 v[16:31], v[216:219], v[124:127], v[16:31]
  v_mfma_f32_32x32x16_bf16 v[32:47], v[220:223], v[124:127], v[32:47]
  ds_read_b128 v[216:219], v4 offset:0
  ds_read_b128 v[220:223], v4 offset:1024
  ds_read_b128 v[224:227], v4 offset:2048
  s_waitcnt vmcnt(0)
  v_add_f32 v6, v240, v242
  v_add_f32 v7, v241, v243
  v_add_f32 v6, v6, v244
  v_add_f32 v7, v7, v245
  v_add_f32 v6, v6, v246
  v_add_f32 v7, v7, v247
  v_add_f32 v6, v6, v248
  v_add_f32 v7, v7, v249
  v_add_f32 v6, v6, v250
  v_add_f32 v7, v7, v251
  v_add_f32 v6, v6, v252
  v_add_f32 v7, v7, v253
  v_add_f32 v6, v6, v254
  v_add_f32 v7, v7, v255
  buffer_load_dwordx2 v[240:241], v12, s[8:11], s53 offen offset:2048 sc1
  buffer_load_dwordx2 v[242:243], v12, s[8:11], s53 offen offset:2304 sc1
  buffer_load_dwordx2 v[244:245], v12, s[8:11], s53 offen offset:2560 sc1
  buffer_load_dwordx2 v[246:247], v12, s[8:11], s53 offen offset:2816 sc1
  buffer_load_dwordx2 v[248:249], v12, s[8:11], s53 offen offset:3072 sc1
  buffer_load_dwordx2 v[250:251], v12, s[8:11], s53 offen offset:3328 sc1
  buffer_load_dwordx2 v[252:253], v12, s[8:11], s53 offen offset:3584 sc1
  buffer_load_dwordx2 v[254:255], v12, s[8:11], s53 offen offset:3840 sc1
  ds_read_b128 v[228:231], v4 offset:3072
  s_waitcnt lgkmcnt(3)
  v_mfma_f32_32x32x16_bf16 v[48:63], v[216:219], v[64:67], v[48:63]
  ds_read_b128 v[216:219], v4 offset:4096
  s_waitcnt lgkmcnt(3)
  v_mfma_f32_32x32x16_bf16 v[48:63], v[220:223], v[68:71], v[48:63]
  ds_read_b128 v[220:223], v4 offset:5120
  s_waitcnt lgkmcnt(3)
  v_mfma_f32_32x32x16_bf16 v[48:63], v[224:227], v[72:75], v[48:63]
  ds_read_b128 v[224:227], v4 offset:6144
  s_waitcnt lgkmcnt(3)
  v_mfma_f32_32x32x16_bf16 v[48:63], v[228:231], v[76:79], v[48:63]
  ds_write_b128 v2, v[16:19] offset:0
  ds_write_b128 v2, v[20:23] offset:1024
  ds_read_b128 v[228:231], v4 offset:7168
  s_waitcnt lgkmcnt(5)
  v_mfma_f32_32x32x16_bf16 v[48:63], v[216:219], v[80:83], v[48:63]
  ds_read_b128 v[216:219], v4 offset:8192
  s_waitcnt lgkmcnt(5)
  v_mfma_f32_32x32x16_bf16 v[48:63], v[220:223], v[84:87], v[48:63]
  ds_read_b128 v[220:223], v4 offset:9216
  s_waitcnt lgkmcnt(5)
  v_mfma_f32_32x32x16_bf16 v[48:63], v[224:227], v[88:91], v[48:63]
  ds_write_b128 v2, v[32:35] offset:2048
  ds_write_b128 v2, v[36:39] offset:3072
  ds_read_b128 v[224:227], v4 offset:10240
  s_waitcnt lgkmcnt(5)
  v_mfma_f32_32x32x16_bf16 v[48:63], v[228:231], v[92:95], v[48:63]
  ds_read_b128 v[228:231], v4 offset:11264
  s_waitcnt lgkmcnt(5)
  v_mfma_f32_32x32x16_bf16 v[48:63], v[216:219], v[96:99], v[48:63]
  ds_read_b128 v[216:219], v4 offset:12288
  s_waitcnt lgkmcnt(5)
  v_mfma_f32_32x32x16_bf16 v[48:63], v[220:223], v[100:103], v[48:63]
  ds_read_b128 v[220:223], v4 offset:13312
  s_waitcnt lgkmcnt(3)
  v_mfma_f32_32x32x16_bf16 v[48:63], v[224:227], v[104:107], v[48:63]
  ds_read_b128 v[224:227], v4 offset:14336
  s_waitcnt lgkmcnt(3)
  v_mfma_f32_32x32x16_bf16 v[48:63], v[228:231], v[108:111], v[48:63]
  ds_read_b128 v[228:231], v4 offset:15360
  s_waitcnt lgkmcnt(3)
  v_mfma_f32_32x32x16_bf16 v[48:63], v[216:219], v[112:115], v[48:63]
  s_waitcnt lgkmcnt(2)
  v_mfma_f32_32x32x16_bf16 v[48:63], v[220:223], v[116:119], v[48:63]
  s_waitcnt lgkmcnt(1)
  v_mfma_f32_32x32x16_bf16 v[48:63], v[224:227], v[120:123], v[48:63]
  s_waitcnt lgkmcnt(0)
  v_mfma_f32_32x32x16_bf16 v[48:63], v[228:231], v[124:127], v[48:63]
  s_waitcnt vmcnt(0)
  v_add_f32 v6, v6, v240
  v_add_f32 v7, v7, v241
  v_add_f32 v6, v6, v242
  v_add_f32 v7, v7, v243
  v_add_f32 v6, v6, v244
  v_add_f32 v7, v7, v245
  v_add_f32 v6, v6, v246
  v_add_f32 v7, v7, v247
  v_add_f32 v6, v6, v248
  v_add_f32 v7, v7, v249
  v_add_f32 v6, v6, v250
  v_add_f32 v7, v7, v251
  v_add_f32 v6, v6, v252
  v_add_f32 v7, v7, v253
  v_add_f32 v6, v6, v254
  v_add_f32 v7, v7, v255
  v_mov_b32 v10, v6
  v_mov_b32 v11, v7
  s_nop 1
  v_permlane32_swap_b32 v6, v10
  v_permlane32_swap_b32 v7, v11
  s_nop 1
  v_add_f32 v6, v6, v10
  v_add_f32 v7, v7, v11
  s_mov_b32 s52, 0x3b000000
  v_mul_f32 v6, s52, v6
  v_mul_f32 v7, s52, v7
  v_fma_f32 v7, -v6, v6, v7
  v_max_f32 v7, 0, v7
  v_add_f32 v7, 0x3727c5ac, v7
  v_rsq_f32 v7, v7
  s_lshl_b32 s52, s46, 7
  s_add_u32 s52, s52, 52992
  v_lshlrev_b32 v10, 2, v8
  v_add_u32 v10, s52, v10
  ds_write_b32 v10, v6
  ds_write_b32 v10, v7 offset:512
  s_nop 15
  ds_write_b128 v2, v[48:51] offset:4096
  ds_write_b128 v2, v[52:55] offset:5120
  v_mov_b32 v16, v24
  v_mov_b32 v17, v25
  v_mov_b32 v18, v26
  v_mov_b32 v19, v27
  v_mov_b32 v20, v28
  v_mov_b32 v21, v29
  v_mov_b32 v22, v30
  v_mov_b32 v23, v31
  v_mov_b32 v32, v40
  v_mov_b32 v33, v41
  v_mov_b32 v34, v42
  v_mov_b32 v35, v43
  v_mov_b32 v36, v44
  v_mov_b32 v37, v45
  v_mov_b32 v38, v46
  v_mov_b32 v39, v47
  v_mov_b32 v48, v56
  v_mov_b32 v49, v57
  v_mov_b32 v50, v58
  v_mov_b32 v51, v59
  v_mov_b32 v52, v60
  v_mov_b32 v53, v61
  v_mov_b32 v54, v62
  v_mov_b32 v55, v63
sequential_preLN__mha_block__dense_activation_squared_relu__prompt_kernel_depi_91:
  v_lshlrev_b32 v13, 4, v9
  s_lshl_b32 s52, s48, 6
  s_add_u32 s52, s52, 52224
  v_add_u32 v13, s52, v13
  ds_read_b128 v[64:67], v13 offset:0
  ds_read_b128 v[88:91], v13 offset:384
  ds_read_b128 v[68:71], v13 offset:32
  ds_read_b128 v[92:95], v13 offset:416
  ds_read_b128 v[72:75], v13 offset:128
  ds_read_b128 v[96:99], v13 offset:512
  ds_read_b128 v[76:79], v13 offset:160
  ds_read_b128 v[100:103], v13 offset:544
  ds_read_b128 v[80:83], v13 offset:256
  ds_read_b128 v[104:107], v13 offset:640
  ds_read_b128 v[84:87], v13 offset:288
  ds_read_b128 v[108:111], v13 offset:672
  s_lshl_b32 s52, s46, 7
  s_add_u32 s52, s52, 52992
  v_lshlrev_b32 v10, 2, v8
  v_add_u32 v10, s52, v10
  s_waitcnt lgkmcnt(0)
  s_barrier
  ds_read_b32 v4, v10
  ds_read_b32 v6, v10 offset:512
  ds_read_b128 v[216:219], v5 offset:0
  ds_read_b128 v[220:223], v5 offset:1024
  ds_read_b128 v[224:227], v5 offset:2048
  ds_read_b128 v[228:231], v5 offset:3072
  ds_read_b128 v[232:235], v5 offset:4096
  ds_read_b128 v[236:239], v5 offset:5120
  s_waitcnt lgkmcnt(4)
  v_pk_add_f32 v[16:17], v[16:17], v[216:217]
  v_pk_add_f32 v[18:19], v[18:19], v[218:219]
  v_pk_add_f32 v[20:21], v[20:21], v[220:221]
  v_pk_add_f32 v[22:23], v[22:23], v[222:223]
  v_pk_fma_f32 v[16:17], v[64:65], v[4:5], v[16:17] op_sel_hi:[1,0,1] neg_lo:[0,1,0] neg_hi:[0,1,0]
  v_pk_fma_f32 v[18:19], v[66:67], v[4:5], v[18:19] op_sel_hi:[1,0,1] neg_lo:[0,1,0] neg_hi:[0,1,0]
  v_pk_fma_f32 v[20:21], v[68:69], v[4:5], v[20:21] op_sel_hi:[1,0,1] neg_lo:[0,1,0] neg_hi:[0,1,0]
  v_pk_fma_f32 v[22:23], v[70:71], v[4:5], v[22:23] op_sel_hi:[1,0,1] neg_lo:[0,1,0] neg_hi:[0,1,0]
  v_pk_fma_f32 v[16:17], v[16:17], v[6:7], v[88:89] op_sel_hi:[1,0,1]
  v_pk_fma_f32 v[18:19], v[18:19], v[6:7], v[90:91] op_sel_hi:[1,0,1]
  v_pk_fma_f32 v[20:21], v[20:21], v[6:7], v[92:93] op_sel_hi:[1,0,1]
  v_pk_fma_f32 v[22:23], v[22:23], v[6:7], v[94:95] op_sel_hi:[1,0,1]
  v_max_f32 v16, 0, v16
  v_max_f32 v17, 0, v17
  v_max_f32 v18, 0, v18
  v_max_f32 v19, 0, v19
  v_max_f32 v20, 0, v20
  v_max_f32 v21, 0, v21
  v_max_f32 v22, 0, v22
  v_max_f32 v23, 0, v23
  v_pk_mul_f32 v[16:17], v[16:17], v[16:17]
  v_pk_mul_f32 v[18:19], v[18:19], v[18:19]
  v_pk_mul_f32 v[20:21], v[20:21], v[20:21]
  v_pk_mul_f32 v[22:23], v[22:23], v[22:23]
  v_cvt_pk_bf16_f32 v112, v16, v17
  v_cvt_pk_bf16_f32 v113, v18, v19
  v_cvt_pk_bf16_f32 v114, v20, v21
  v_cvt_pk_bf16_f32 v115, v22, v23
  s_add_u32 s52, s57, 0
  s_lshl_b32 s52, s52, 1
  s_add_u32 s52, s52, s48
  s_mul_i32 s53, s47, 86
  s_add_u32 s53, s53, s52
  s_lshl_b32 s53, s53, 10
  s_add_u32 s53, s53, 11534336
  buffer_store_dwordx4 v[112:115], v1, s[8:11], s53 offen sc1
  s_waitcnt lgkmcnt(2)
  v_pk_add_f32 v[32:33], v[32:33], v[224:225]
  v_pk_add_f32 v[34:35], v[34:35], v[226:227]
  v_pk_add_f32 v[36:37], v[36:37], v[228:229]
  v_pk_add_f32 v[38:39], v[38:39], v[230:231]
  v_pk_fma_f32 v[32:33], v[72:73], v[4:5], v[32:33] op_sel_hi:[1,0,1] neg_lo:[0,1,0] neg_hi:[0,1,0]
  v_pk_fma_f32 v[34:35], v[74:75], v[4:5], v[34:35] op_sel_hi:[1,0,1] neg_lo:[0,1,0] neg_hi:[0,1,0]
  v_pk_fma_f32 v[36:37], v[76:77], v[4:5], v[36:37] op_sel_hi:[1,0,1] neg_lo:[0,1,0] neg_hi:[0,1,0]
  v_pk_fma_f32 v[38:39], v[78:79], v[4:5], v[38:39] op_sel_hi:[1,0,1] neg_lo:[0,1,0] neg_hi:[0,1,0]
  v_pk_fma_f32 v[32:33], v[32:33], v[6:7], v[96:97] op_sel_hi:[1,0,1]
  v_pk_fma_f32 v[34:35], v[34:35], v[6:7], v[98:99] op_sel_hi:[1,0,1]
  v_pk_fma_f32 v[36:37], v[36:37], v[6:7], v[100:101] op_sel_hi:[1,0,1]
  v_pk_fma_f32 v[38:39], v[38:39], v[6:7], v[102:103] op_sel_hi:[1,0,1]
  v_max_f32 v32, 0, v32
  v_max_f32 v33, 0, v33
  v_max_f32 v34, 0, v34
  v_max_f32 v35, 0, v35
  v_max_f32 v36, 0, v36
  v_max_f32 v37, 0, v37
  v_max_f32 v38, 0, v38
  v_max_f32 v39, 0, v39
  v_pk_mul_f32 v[32:33], v[32:33], v[32:33]
  v_pk_mul_f32 v[34:35], v[34:35], v[34:35]
  v_pk_mul_f32 v[36:37], v[36:37], v[36:37]
  v_pk_mul_f32 v[38:39], v[38:39], v[38:39]
  v_cvt_pk_bf16_f32 v116, v32, v33
  v_cvt_pk_bf16_f32 v117, v34, v35
  v_cvt_pk_bf16_f32 v118, v36, v37
  v_cvt_pk_bf16_f32 v119, v38, v39
  s_add_u32 s52, s57, 1
  s_lshl_b32 s52, s52, 1
  s_add_u32 s52, s52, s48
  s_mul_i32 s53, s47, 86
  s_add_u32 s53, s53, s52
  s_lshl_b32 s53, s53, 10
  s_add_u32 s53, s53, 11534336
  buffer_store_dwordx4 v[116:119], v1, s[8:11], s53 offen sc1
  s_waitcnt lgkmcnt(0)
  v_pk_add_f32 v[48:49], v[48:49], v[232:233]
  v_pk_add_f32 v[50:51], v[50:51], v[234:235]
  v_pk_add_f32 v[52:53], v[52:53], v[236:237]
  v_pk_add_f32 v[54:55], v[54:55], v[238:239]
  v_pk_fma_f32 v[48:49], v[80:81], v[4:5], v[48:49] op_sel_hi:[1,0,1] neg_lo:[0,1,0] neg_hi:[0,1,0]
  v_pk_fma_f32 v[50:51], v[82:83], v[4:5], v[50:51] op_sel_hi:[1,0,1] neg_lo:[0,1,0] neg_hi:[0,1,0]
  v_pk_fma_f32 v[52:53], v[84:85], v[4:5], v[52:53] op_sel_hi:[1,0,1] neg_lo:[0,1,0] neg_hi:[0,1,0]
  v_pk_fma_f32 v[54:55], v[86:87], v[4:5], v[54:55] op_sel_hi:[1,0,1] neg_lo:[0,1,0] neg_hi:[0,1,0]
  v_pk_fma_f32 v[48:49], v[48:49], v[6:7], v[104:105] op_sel_hi:[1,0,1]
  v_pk_fma_f32 v[50:51], v[50:51], v[6:7], v[106:107] op_sel_hi:[1,0,1]
  v_pk_fma_f32 v[52:53], v[52:53], v[6:7], v[108:109] op_sel_hi:[1,0,1]
  v_pk_fma_f32 v[54:55], v[54:55], v[6:7], v[110:111] op_sel_hi:[1,0,1]
  v_max_f32 v48, 0, v48
  v_max_f32 v49, 0, v49
  v_max_f32 v50, 0, v50
  v_max_f32 v51, 0, v51
  v_max_f32 v52, 0, v52
  v_max_f32 v53, 0, v53
  v_max_f32 v54, 0, v54
  v_max_f32 v55, 0, v55
  v_pk_mul_f32 v[48:49], v[48:49], v[48:49]
  v_pk_mul_f32 v[50:51], v[50:51], v[50:51]
  v_pk_mul_f32 v[52:53], v[52:53], v[52:53]
  v_pk_mul_f32 v[54:55], v[54:55], v[54:55]
  v_cvt_pk_bf16_f32 v120, v48, v49
  v_cvt_pk_bf16_f32 v121, v50, v51
  v_cvt_pk_bf16_f32 v122, v52, v53
  v_cvt_pk_bf16_f32 v123, v54, v55
  s_cmp_lt_u32 s59, 3
  s_cbranch_scc1 sequential_preLN__mha_block__dense_activation_squared_relu__prompt_kernel_e3_93
  s_add_u32 s52, s57, 2
  s_lshl_b32 s52, s52, 1
  s_add_u32 s52, s52, s48
  s_mul_i32 s53, s47, 86
  s_add_u32 s53, s53, s52
  s_lshl_b32 s53, s53, 10
  s_add_u32 s53, s53, 11534336
  buffer_store_dwordx4 v[120:123], v1, s[8:11], s53 offen sc1
sequential_preLN__mha_block__dense_activation_squared_relu__prompt_kernel_e3_93:
  s_waitcnt vmcnt(0)
  s_barrier
  s_cmp_lg_u32 s3, 0
  s_cbranch_scc1 sequential_preLN__mha_block__dense_activation_squared_relu__prompt_kernel_nw0_94
  s_lshl_b32 s62, s55, 4
  s_add_u32 s62, s62, s56
  s_lshl_b32 s62, s62, 7
  s_add_u32 s62, s62, 23166976
  v_mov_b32 v2, 0
  v_mov_b32 v3, s4
  s_mov_b64 exec, 1
  buffer_store_dword v3, v2, s[8:11], s62 offen sc1
  s_mov_b64 exec, -1
sequential_preLN__mha_block__dense_activation_squared_relu__prompt_kernel_nw0_94:
  s_and_b32 s46, s3, 1
  s_lshr_b32 s47, s3, 1
  s_lshl_b32 s48, s6, 1
  s_add_u32 s48, s48, s46
  s_lshr_b32 s49, s47, 1
  s_lshl_b32 s62, s5, 1
  s_add_u32 s49, s49, s62
  s_and_b32 s62, s47, 1
  s_lshl_b32 s63, s48, 1
  s_add_u32 s62, s62, s63
  s_mov_b32 s57, s49
  s_mov_b32 s59, s62
  s_lshl_b32 s63, s49, 5
  s_add_u32 s63, s63, s62
  s_lshl_b32 s63, s63, 10
  s_add_u32 s63, s63, 8388608
  buffer_load_dwordx4 v[80:83], v1, s[8:11], s63 offen sc1
  s_mov_b32 s20, s38
  s_and_b32 s21, s39, 0xffff
  s_mov_b32 s22, 1024
  s_mov_b32 s23, 0x20000
  v_lshrrev_b32 v9, 5, v0
  v_lshlrev_b32 v12, 3, v9
  s_lshl_b32 s63, s62, 5
  buffer_load_dwordx2 v[84:85], v12, s[20:23], s63 offen
  buffer_load_dwordx2 v[86:87], v12, s[20:23], s63 offen offset:16
  s_lshl_b32 s62, s5, 1
  s_add_u32 s62, s62, s46
  s_mul_i32 s62, s62, 86
  s_mul_i32 s63, s47, 22
  s_add_u32 s62, s62, s63
  s_lshl_b32 s62, s62, 10
  s_add_u32 s55, s62, 11534336
  s_lshl_b32 s56, s3, 11
  v_mov_b32 v16, 0
  v_mov_b32 v17, 0
  v_mov_b32 v18, 0
  v_mov_b32 v19, 0
  v_mov_b32 v20, 0
  v_mov_b32 v21, 0
  v_mov_b32 v22, 0
  v_mov_b32 v23, 0
  v_mov_b32 v24, 0
  v_mov_b32 v25, 0
  v_mov_b32 v26, 0
  v_mov_b32 v27, 0
  v_mov_b32 v28, 0
  v_mov_b32 v29, 0
  v_mov_b32 v30, 0
  v_mov_b32 v31, 0
  v_mov_b32 v32, 0
  v_mov_b32 v33, 0
  v_mov_b32 v34, 0
  v_mov_b32 v35, 0
  v_mov_b32 v36, 0
  v_mov_b32 v37, 0
  v_mov_b32 v38, 0
  v_mov_b32 v39, 0
  v_mov_b32 v40, 0
  v_mov_b32 v41, 0
  v_mov_b32 v42, 0
  v_mov_b32 v43, 0
  v_mov_b32 v44, 0
  v_mov_b32 v45, 0
  v_mov_b32 v46, 0
  v_mov_b32 v47, 0
  s_lshl_b32 s62, s47, 12
  v_add_u32 v2, s62, v1
  v_add_u32 v3, 65536, v2
  v_add_u32 v4, 131072, v2
  s_cmp_lg_u32 s3, 0
  s_cbranch_scc1 sequential_preLN__mha_block__dense_activation_squared_relu__prompt_kernel_nw0_95
  s_lshr_b32 s51, s5, 1
  s_lshl_b32 s51, s51, 11
  s_add_u32 s51, s51, 23166976
  v_lshlrev_b32 v92, 7, v0
  s_mov_b32 exec_lo, 0xffff
  s_mov_b32 exec_hi, 0x0
  s_mov_b32 s58, 0
sequential_preLN__mha_block__dense_activation_squared_relu__prompt_kernel_poll_96:
  buffer_load_dword v93, v92, s[8:11], s51 offen sc1
sequential_preLN__mha_block__dense_activation_squared_relu__prompt_kernel_pchk_98:
  s_add_u32 s58, s58, 1
  s_waitcnt vmcnt(0)
  v_cmp_eq_u32 vcc, s4, v93
  s_cmp_gt_u32 s58, 200000
  s_cbranch_scc1 sequential_preLN__mha_block__dense_activation_squared_relu__prompt_kernel_pdone_97
  s_cmp_eq_u64 vcc, exec
  s_cbranch_scc0 sequential_preLN__mha_block__dense_activation_squared_relu__prompt_kernel_poll_96
sequential_preLN__mha_block__dense_activation_squared_relu__prompt_kernel_pdone_97:
  s_mov_b64 exec, -1
sequential_preLN__mha_block__dense_activation_squared_relu__prompt_kernel_nw0_95:
  s_barrier
  s_add_u32 m0, s56, 0
  s_add_u32 s62, s55, 0
  buffer_load_dwordx4 v1, s[8:11], s62 offen sc1 lds
  s_add_u32 m0, s56, 1024
  s_add_u32 s62, s55, 1024
  buffer_load_dwordx4 v1, s[8:11], s62 offen sc1 lds
  s_barrier
  s_add_u32 m0, s56, 16384
  s_add_u32 s62, s55, 2048
  buffer_load_dwordx4 v1, s[8:11], s62 offen sc1 lds
  s_add_u32 m0, s56, 17408
  s_add_u32 s62, s55, 3072
  buffer_load_dwordx4 v1, s[8:11], s62 offen sc1 lds
  s_barrier
  s_add_u32 m0, s56, 32768
  s_add_u32 s62, s55, 4096
  buffer_load_dwordx4 v1, s[8:11], s62 offen sc1 lds
  s_add_u32 m0, s56, 33792
  s_add_u32 s62, s55, 5120
  buffer_load_dwordx4 v1, s[8:11], s62 offen sc1 lds
  s_waitcnt vmcnt(4)
  s_barrier
  ds_read_b128 v[48:51], v2 offset:0
  ds_read_b128 v[52:55], v2 offset:2048
  ds_read_b128 v[56:59], v2 offset:1024
  ds_read_b128 v[60:63], v2 offset:3072
  s_add_u32 m0, s56, 49152
  s_add_u32 s62, s55, 6144
  buffer_load_dwordx4 v1, s[8:11], s62 offen sc1 lds
  s_add_u32 m0, s56, 50176
  s_add_u32 s62, s55, 7168
  buffer_load_dwordx4 v1, s[8:11], s62 offen sc1 lds
  s_add_u32 m0, s56, 65536
  s_add_u32 s62, s55, 8192
  buffer_load_dwordx4 v1, s[8:11], s62 offen sc1 lds
  s_add_u32 m0, s56, 66560
  s_add_u32 s62, s55, 9216
  buffer_load_dwordx4 v1, s[8:11], s62 offen sc1 lds
  s_waitcnt lgkmcnt(0)
  v_mfma_f32_32x32x16_bf16 v[16:31], v[128:131], v[48:51], v[16:31]
  s_waitcnt vmcnt(6)
  s_barrier
  ds_read_b128 v[64:67], v2 offset:16384
  ds_read_b128 v[68:71], v2 offset:18432
  v_mfma_f32_32x32x16_bf16 v[32:47], v[128:131], v[52:55], v[32:47]
  ds_read_b128 v[72:75], v2 offset:17408
  ds_read_b128 v[76:79], v2 offset:19456
  v_mfma_f32_32x32x16_bf16 v[16:31], v[132:135], v[56:59], v[16:31]
  s_add_u32 m0, s56, 81920
  s_add_u32 s62, s55, 10240
  buffer_load_dwordx4 v1, s[8:11], s62 offen sc1 lds
  v_mfma_f32_32x32x16_bf16 v[32:47], v[132:135], v[60:63], v[32:47]
  s_add_u32 m0, s56, 82944
  s_add_u32 s62, s55, 11264
  buffer_load_dwordx4 v1, s[8:11], s62 offen sc1 lds
  s_waitcnt lgkmcnt(0)
  v_mfma_f32_32x32x16_bf16 v[16:31], v[136:139], v[64:67], v[16:31]
  s_waitcnt vmcnt(6)
  s_barrier
  ds_read_b128 v[48:51], v2 offset:32768
  ds_read_b128 v[52:55], v2 offset:34816
  v_mfma_f32_32x32x16_bf16 v[32:47], v[136:139], v[68:71], v[32:47]
  ds_read_b128 v[56:59], v2 offset:33792
  ds_read_b128 v[60:63], v2 offset:35840
  v_mfma_f32_32x32x16_bf16 v[16:31], v[140:143], v[72:75], v[16:31]
  s_add_u32 m0, s56, 98304
  s_add_u32 s62, s55, 12288
  buffer_load_dwordx4 v1, s[8:11], s62 offen sc1 lds
  v_mfma_f32_32x32x16_bf16 v[32:47], v[140:143], v[76:79], v[32:47]
  s_add_u32 m0, s56, 99328
  s_add_u32 s62, s55, 13312
  buffer_load_dwordx4 v1, s[8:11], s62 offen sc1 lds
  s_waitcnt lgkmcnt(0)
  v_mfma_f32_32x32x16_bf16 v[16:31], v[144:147], v[48:51], v[16:31]
  s_waitcnt vmcnt(6)
  s_barrier
  ds_read_b128 v[64:67], v2 offset:49152
  ds_read_b128 v[68:71], v2 offset:51200
  v_mfma_f32_32x32x16_bf16 v[32:47], v[144:147], v[52:55], v[32:47]
  ds_read_b128 v[72:75], v2 offset:50176
  ds_read_b128 v[76:79], v2 offset:52224
  v_mfma_f32_32x32x16_bf16 v[16:31], v[148:151], v[56:59], v[16:31]
  s_add_u32 m0, s56, 114688
  s_add_u32 s62, s55, 14336
  buffer_load_dwordx4 v1, s[8:11], s62 offen sc1 lds
  v_mfma_f32_32x32x16_bf16 v[32:47], v[148:151], v[60:63], v[32:47]
  s_add_u32 m0, s56, 115712
  s_add_u32 s62, s55, 15360
  buffer_load_dwordx4 v1, s[8:11], s62 offen sc1 lds
  s_waitcnt lgkmcnt(0)
  v_mfma_f32_32x32x16_bf16 v[16:31], v[152:155], v[64:67], v[16:31]
  s_waitcnt vmcnt(6)
  s_barrier
  ds_read_b128 v[48:51], v3 offset:0
  ds_read_b128 v[52:55], v3 offset:2048
  v_mfma_f32_32x32x16_bf16 v[32:47], v[152:155], v[68:71], v[32:47]
  ds_read_b128 v[56:59], v3 offset:1024
  ds_read_b128 v[60:63], v3 offset:3072
  v_mfma_f32_32x32x16_bf16 v[16:31], v[156:159], v[72:75], v[16:31]
  s_add_u32 m0, s56, 131072
  s_add_u32 s62, s55, 16384
  buffer_load_dwordx4 v1, s[8:11], s62 offen sc1 lds
  v_mfma_f32_32x32x16_bf16 v[32:47], v[156:159], v[76:79], v[32:47]
  s_add_u32 m0, s56, 132096
  s_add_u32 s62, s55, 17408
  buffer_load_dwordx4 v1, s[8:11], s62 offen sc1 lds
  s_waitcnt lgkmcnt(0)
  v_mfma_f32_32x32x16_bf16 v[16:31], v[160:163], v[48:51], v[16:31]
  s_waitcnt vmcnt(6)
  s_barrier
  ds_read_b128 v[64:67], v3 offset:16384
  ds_read_b128 v[68:71], v3 offset:18432
  v_mfma_f32_32x32x16_bf16 v[32:47], v[160:163], v[52:55], v[32:47]
  ds_read_b128 v[72:75], v3 offset:17408
  ds_read_b128 v[76:79], v3 offset:19456
  v_mfma_f32_32x32x16_bf16 v[16:31], v[164:167], v[56:59], v[16:31]
  s_add_u32 m0, s56, 0
  s_add_u32 s62, s55, 18432
  buffer_load_dwordx4 v1, s[8:11], s62 offen sc1 lds
  v_mfma_f32_32x32x16_bf16 v[32:47], v[164:167], v[60:63], v[32:47]
  s_add_u32 m0, s56, 1024
  s_add_u32 s62, s55, 19456
  buffer_load_dwordx4 v1, s[8:11], s62 offen sc1 lds
  s_waitcnt lgkmcnt(0)
  v_mfma_f32_32x32x16_bf16 v[16:31], v[168:171], v[64:67], v[16:31]
  s_waitcnt vmcnt(6)
  s_barrier
  ds_read_b128 v[48:51], v3 offset:32768
  ds_read_b128 v[52:55], v3 offset:34816
  v_mfma_f32_32x32x16_bf16 v[32:47], v[168:171], v[68:71], v[32:47]
  ds_read_b128 v[56:59], v3 offset:33792
  ds_read_b128 v[60:63], v3 offset:35840
  v_mfma_f32_32x32x16_bf16 v[16:31], v[172:175], v[72:75], v[16:31]
  s_add_u32 m0, s56, 16384
  s_add_u32 s62, s55, 20480
  buffer_load_dwordx4 v1, s[8:11], s62 offen sc1 lds
  v_mfma_f32_32x32x16_bf16 v[32:47], v[172:175], v[76:79], v[32:47]
  s_add_u32 m0, s56, 17408
  s_add_u32 s62, s55, 21504
  buffer_load_dwordx4 v1, s[8:11], s62 offen sc1 lds
  s_waitcnt lgkmcnt(0)
  v_mfma_f32_32x32x16_bf16 v[16:31], v[176:179], v[48:51], v[16:31]
  s_waitcnt vmcnt(6)
  s_barrier
  ds_read_b128 v[64:67], v3 offset:49152
  ds_read_b128 v[68:71], v3 offset:51200
  v_mfma_f32_32x32x16_bf16 v[32:47], v[176:179], v[52:55], v[32:47]
  ds_read_b128 v[72:75], v3 offset:50176
  ds_read_b128 v[76:79], v3 offset:52224
  v_mfma_f32_32x32x16_bf16 v[16:31], v[180:183], v[56:59], v[16:31]
  v_mfma_f32_32x32x16_bf16 v[32:47], v[180:183], v[60:63], v[32:47]
  s_waitcnt lgkmcnt(0)
  v_mfma_f32_32x32x16_bf16 v[16:31], v[184:187], v[64:67], v[16:31]
  s_waitcnt vmcnt(4)
  s_barrier
  ds_read_b128 v[48:51], v4 offset:0
  ds_read_b128 v[52:55], v4 offset:2048
  v_mfma_f32_32x32x16_bf16 v[32:47], v[184:187], v[68:71], v[32:47]
  ds_read_b128 v[56:59], v4 offset:1024
  ds_read_b128 v[60:63], v4 offset:3072
  v_mfma_f32_32x32x16_bf16 v[16:31], v[188:191], v[72:75], v[16:31]
  v_mfma_f32_32x32x16_bf16 v[32:47], v[188:191], v[76:79], v[32:47]
  s_waitcnt lgkmcnt(0)
  v_mfma_f32_32x32x16_bf16 v[16:31], v[192:195], v[48:51], v[16:31]
  s_waitcnt vmcnt(2)
  s_barrier
  ds_read_b128 v[64:67], v2 offset:0
  ds_read_b128 v[68:71], v2 offset:2048
  v_mfma_f32_32x32x16_bf16 v[32:47], v[192:195], v[52:55], v[32:47]
  ds_read_b128 v[72:75], v2 offset:1024
  ds_read_b128 v[76:79], v2 offset:3072
  v_mfma_f32_32x32x16_bf16 v[16:31], v[196:199], v[56:59], v[16:31]
  v_mfma_f32_32x32x16_bf16 v[32:47], v[196:199], v[60:63], v[32:47]
  s_waitcnt lgkmcnt(0)
  v_mfma_f32_32x32x16_bf16 v[16:31], v[200:203], v[64:67], v[16:31]
  s_waitcnt vmcnt(0)
  s_barrier
  ds_read_b128 v[48:51], v2 offset:16384
  ds_read_b128 v[52:55], v2 offset:18432
  v_mfma_f32_32x32x16_bf16 v[32:47], v[200:203], v[68:71], v[32:47]
  ds_read_b128 v[56:59], v2 offset:17408
  ds_read_b128 v[60:63], v2 offset:19456
  v_mfma_f32_32x32x16_bf16 v[16:31], v[204:207], v[72:75], v[16:31]
  v_mfma_f32_32x32x16_bf16 v[32:47], v[204:207], v[76:79], v[32:47]
  s_waitcnt lgkmcnt(0)
  s_cmp_eq_u32 s47, 3
  s_cbranch_scc1 sequential_preLN__mha_block__dense_activation_squared_relu__prompt_kernel_esk_99
  v_mfma_f32_32x32x16_bf16 v[16:31], v[208:211], v[48:51], v[16:31]
  v_mfma_f32_32x32x16_bf16 v[32:47], v[208:211], v[52:55], v[32:47]
  v_mfma_f32_32x32x16_bf16 v[16:31], v[212:215], v[56:59], v[16:31]
  v_mfma_f32_32x32x16_bf16 v[32:47], v[212:215], v[60:63], v[32:47]
sequential_preLN__mha_block__dense_activation_squared_relu__prompt_kernel_esk_99:
  s_nop 15
  s_nop 3
  s_lshl_b32 s62, s46, 15
  s_lshl_b32 s63, s47, 11
  s_add_u32 s62, s62, s63
  s_add_u32 s62, s62, 32768
  v_add_u32 v2, s62, v1
  s_cmp_lg_u32 s47, 0
  s_cbranch_scc1 sequential_preLN__mha_block__dense_activation_squared_relu__prompt_kernel_er_100
  ds_write_b128 v2, v[24:27] offset:8192
  ds_write_b128 v2, v[28:31] offset:9216
  ds_write_b128 v2, v[32:35] offset:16384
  ds_write_b128 v2, v[36:39] offset:17408
  ds_write_b128 v2, v[40:43] offset:24576
  ds_write_b128 v2, v[44:47] offset:25600
  v_mov_b32 v48, v16
  v_mov_b32 v49, v17
  v_mov_b32 v50, v18
  v_mov_b32 v51, v19
  v_mov_b32 v52, v20
  v_mov_b32 v53, v21
  v_mov_b32 v54, v22
  v_mov_b32 v55, v23
  s_branch sequential_preLN__mha_block__dense_activation_squared_relu__prompt_kernel_erj_104
sequential_preLN__mha_block__dense_activation_squared_relu__prompt_kernel_er_100:
  s_cmp_lg_u32 s47, 1
  s_cbranch_scc1 sequential_preLN__mha_block__dense_activation_squared_relu__prompt_kernel_er_101
  ds_write_b128 v2, v[16:19] offset:0
  ds_write_b128 v2, v[20:23] offset:1024
  ds_write_b128 v2, v[32:35] offset:16384
  ds_write_b128 v2, v[36:39] offset:17408
  ds_write_b128 v2, v[40:43] offset:24576
  ds_write_b128 v2, v[44:47] offset:25600
  v_mov_b32 v48, v24
  v_mov_b32 v49, v25
  v_mov_b32 v50, v26
  v_mov_b32 v51, v27
  v_mov_b32 v52, v28
  v_mov_b32 v53, v29
  v_mov_b32 v54, v30
  v_mov_b32 v55, v31
  s_branch sequential_preLN__mha_block__dense_activation_squared_relu__prompt_kernel_erj_104
sequential_preLN__mha_block__dense_activation_squared_relu__prompt_kernel_er_101:
  s_cmp_lg_u32 s47, 2
  s_cbranch_scc1 sequential_preLN__mha_block__dense_activation_squared_relu__prompt_kernel_er_102
  ds_write_b128 v2, v[16:19] offset:0
  ds_write_b128 v2, v[20:23] offset:1024
  ds_write_b128 v2, v[24:27] offset:8192
  ds_write_b128 v2, v[28:31] offset:9216
  ds_write_b128 v2, v[40:43] offset:24576
  ds_write_b128 v2, v[44:47] offset:25600
  v_mov_b32 v48, v32
  v_mov_b32 v49, v33
  v_mov_b32 v50, v34
  v_mov_b32 v51, v35
  v_mov_b32 v52, v36
  v_mov_b32 v53, v37
  v_mov_b32 v54, v38
  v_mov_b32 v55, v39
  s_branch sequential_preLN__mha_block__dense_activation_squared_relu__prompt_kernel_erj_104
sequential_preLN__mha_block__dense_activation_squared_relu__prompt_kernel_er_102:
  ds_write_b128 v2, v[16:19] offset:0
  ds_write_b128 v2, v[20:23] offset:1024
  ds_write_b128 v2, v[24:27] offset:8192
  ds_write_b128 v2, v[28:31] offset:9216
  ds_write_b128 v2, v[32:35] offset:16384
  ds_write_b128 v2, v[36:39] offset:17408
  v_mov_b32 v48, v40
  v_mov_b32 v49, v41
  v_mov_b32 v50, v42
  v_mov_b32 v51, v43
  v_mov_b32 v52, v44
  v_mov_b32 v53, v45
  v_mov_b32 v54, v46
  v_mov_b32 v55, v47
sequential_preLN__mha_block__dense_activation_squared_relu__prompt_kernel_erj_104:
  s_lshl_b32 s62, s46, 15
  s_lshl_b32 s63, s47, 13
  s_add_u32 s62, s62, s63
  s_add_u32 s62, s62, 32768
  v_add_u32 v3, s62, v1
  s_waitcnt lgkmcnt(0)
  s_barrier
  s_add_u32 s62, s47, 1
  s_and_b32 s62, s62, 3
  s_lshl_b32 s62, s62, 11
  v_add_u32 v4, s62, v3
  ds_read_b128 v[16:19], v4
  ds_read_b128 v[20:23], v4 offset:1024
  s_add_u32 s62, s47, 2
  s_and_b32 s62, s62, 3
  s_lshl_b32 s62, s62, 11
  v_add_u32 v5, s62, v3
  ds_read_b128 v[24:27], v5
  ds_read_b128 v[28:31], v5 offset:1024
  s_add_u32 s62, s47, 3
  s_and_b32 s62, s62, 3
  s_lshl_b32 s62, s62, 11
  v_add_u32 v6, s62, v3
  ds_read_b128 v[32:35], v6
  ds_read_b128 v[36:39], v6 offset:1024
  s_waitcnt lgkmcnt(0)
  v_add_f32 v16, v16, v24
  v_add_f32 v17, v17, v25
  v_add_f32 v18, v18, v26
  v_add_f32 v19, v19, v27
  v_add_f32 v20, v20, v28
  v_add_f32 v21, v21, v29
  v_add_f32 v22, v22, v30
  v_add_f32 v23, v23, v31
  v_add_f32 v32, v32, v48
  v_add_f32 v33, v33, v49
  v_add_f32 v34, v34, v50
  v_add_f32 v35, v35, v51
  v_add_f32 v36, v36, v52
  v_add_f32 v37, v37, v53
  v_add_f32 v38, v38, v54
  v_add_f32 v39, v39, v55
  v_add_f32 v16, v16, v32
  v_add_f32 v17, v17, v33
  v_add_f32 v18, v18, v34
  v_add_f32 v19, v19, v35
  v_add_f32 v20, v20, v36
  v_add_f32 v21, v21, v37
  v_add_f32 v22, v22, v38
  v_add_f32 v23, v23, v39
  s_waitcnt vmcnt(0)
  v_lshlrev_b32 v88, 16, v80
  v_and_b32 v89, 0xffff0000, v80
  v_lshlrev_b32 v90, 16, v84
  v_and_b32 v91, 0xffff0000, v84
  v_add_f32 v16, v16, v90
  v_add_f32 v17, v17, v91
  v_add_f32 v16, v16, v88
  v_add_f32 v17, v17, v89
  v_lshlrev_b32 v88, 16, v81
  v_and_b32 v89, 0xffff0000, v81
  v_lshlrev_b32 v90, 16, v85
  v_and_b32 v91, 0xffff0000, v85
  v_add_f32 v18, v18, v90
  v_add_f32 v19, v19, v91
  v_add_f32 v18, v18, v88
  v_add_f32 v19, v19, v89
  v_lshlrev_b32 v88, 16, v82
  v_and_b32 v89, 0xffff0000, v82
  v_lshlrev_b32 v90, 16, v86
  v_and_b32 v91, 0xffff0000, v86
  v_add_f32 v20, v20, v90
  v_add_f32 v21, v21, v91
  v_add_f32 v20, v20, v88
  v_add_f32 v21, v21, v89
  v_lshlrev_b32 v88, 16, v83
  v_and_b32 v89, 0xffff0000, v83
  v_lshlrev_b32 v90, 16, v87
  v_and_b32 v91, 0xffff0000, v87
  v_add_f32 v22, v22, v90
  v_add_f32 v23, v23, v91
  v_add_f32 v22, v22, v88
  v_add_f32 v23, v23, v89
  v_cvt_pk_bf16_f32 v88, v16, v17
  v_cvt_pk_bf16_f32 v89, v18, v19
  v_cvt_pk_bf16_f32 v90, v20, v21
  v_cvt_pk_bf16_f32 v91, v22, v23
  s_nop 1
  v_permlane32_swap_b32 v88, v90
  v_permlane32_swap_b32 v89, v91
  s_mov_b32 s20, s40
  s_and_b32 s21, s41, 0xffff
  s_mov_b32 s22, 2097152
  s_mov_b32 s23, 0x20000
  v_and_b32 v8, 31, v0
  s_lshl_b32 s62, s57, 5
  v_add_u32 v11, s62, v8
  v_lshlrev_b32 v12, 10, v11
  v_lshrrev_b32 v9, 5, v0
  v_lshl_add_u32 v12, v9, 4, v12
  s_lshl_b32 s63, s59, 5
  buffer_store_dwordx4 v[88:91], v12, s[20:23], s63 offen
  s_waitcnt vmcnt(0)
  s_waitcnt vmcnt(0)
  s_endpgm
sequential_preLN__mha_block__dense_activation_squared_relu__prompt_kernel_end:
  s_endpgm
sequential_preLN__mha_block__dense_activation_squared_relu__prompt_kernel_codeend:
.section .rodata,"a"
.p2align 6
.amdhsa_kernel sequential_preLN__mha_block__dense_activation_squared_relu__prompt_kernel
  .amdhsa_next_free_vgpr 256
  .amdhsa_next_free_sgpr 102
  .amdhsa_accum_offset 256
  .amdhsa_group_segment_fixed_size 0
  .amdhsa_kernarg_size 88
  .amdhsa_user_sgpr_count 2
  .amdhsa_user_sgpr_kernarg_segment_ptr 1
  .amdhsa_system_sgpr_workgroup_id_x 1
  .amdhsa_float_denorm_mode_32 3
.end_amdhsa_kernel
```
